```python
import torch

def _softmax(x, axis=-1):
    return torch.softmax(x, dim=axis)
def _gelu(x):
    return torch.nn.functional.gelu(x, approximate="tanh")
def _silu(x):
    return torch.nn.functional.silu(x)
def _sigmoid(x):
    return torch.sigmoid(x)
def _layernorm(x, axis=-1, eps=1e-5):
    m = x.mean(dim=axis, keepdim=True)
    v = x.var(dim=axis, keepdim=True, unbiased=False)
    return (x - m) / torch.sqrt(v + eps)
def _scatter_add(tgt, idx, src, axis=0):
    return tgt.clone().index_add_(axis, idx, src)
def _segment_sum(src, seg, n):
    out = torch.zeros((n,) + src.shape[1:], dtype=src.dtype)
    return out.index_add_(0, seg, src)
def _pad(x, pw):
    flat = tuple(v for pair in reversed(pw) for v in pair)
    return torch.nn.functional.pad(x, flat)

kernel_name = 'standalone__gqa_softmax__near_ridge'

def setup_inputs():

    _w = (lambda a: (lambda t: t.to(torch.bfloat16) if t.is_floating_point() else t)(torch.as_tensor(a)))
    B, Hq, Hkv, Sq, Sk, D = 32, 32, 8, 64, 512, 128
    return {
        "q": _w((lambda *s: torch.randn(*s, dtype=torch.bfloat16) * 0.8)(B, Hq, Sq, D)),
        "k": _w((lambda *s: torch.randn(*s, dtype=torch.bfloat16) * 0.8)(B, Hkv, Sk, D)),
        "v": _w((lambda *s: torch.randn(*s, dtype=torch.bfloat16) * 0.05)(B, Hkv, Sk, D)),
    }

def reference(q, k, v):
    B, Hq, Sq, D = q.shape
    Hkv = k.shape[1]
    rep = Hq // Hkv
    k = (lambda x, n, axis: torch.repeat_interleave(x, n, dim=axis))(k, rep, axis=1)
    v = (lambda x, n, axis: torch.repeat_interleave(x, n, dim=axis))(v, rep, axis=1)
    scale = D ** -0.5
    scores = torch.einsum("bhqd,bhkd->bhqk", q, k) * scale
    p = _softmax(scores, axis=-1)
    return torch.einsum("bhqk,bhkd->bhqd", p, v)
```

```asm
; @launch grid=(256,1,1) block=(256,1,1) lds=163840
.amdgcn_target "amdgcn-amd-amdhsa--gfx950"
.text
.globl standalone__gqa_softmax__near_ridge_kernel
.p2align 8
.type standalone__gqa_softmax__near_ridge_kernel,@function
standalone__gqa_softmax__near_ridge_kernel:
    s_cmp_ge_u32 s2, 256
    s_cbranch_scc1 L_end
    s_load_dwordx8 s[4:11], s[0:1], 0
    s_getpc_b64 s[96:97]
L_pc:
    s_add_u32 s96, s96, L_main-L_pc
    s_addc_u32 s97, s97, 0
    s_mov_b32 s98, L_codeend-L_main
    s_mov_b32 s99, 0x20000
    s_lshr_b32 s95, s2, 3
    s_lshl_b32 s95, s95, 10
    v_lshlrev_b32 v16, 2, v0
    buffer_load_dword v144, v16, s[96:99], s95 offen
    s_and_b32 s35, s2, 7
    s_lshl_b32 s35, s35, 5
    s_lshr_b32 s2, s2, 3
    s_or_b32 s2, s2, s35
    s_mov_b32 s29, 0
L_start:
    v_lshrrev_b32 v12, 6, v0
    v_and_b32 v152, 63, v0
    v_readfirstlane_b32 s3, v12
    v_lshrrev_b32 v13, 4, v152
    v_and_b32 v14, 2, v13
    v_xor_b32 v14, v14, v152
    v_lshl_add_u32 v156, v14, 4, 64
    v_add_u32 v157, 4294967232, v156
    v_lshlrev_b32 v12, 11, v12
    v_add_u32 v6, v12, v156
    v_add_u32 v7, 4294967232, v6
    v_and_b32 v14, 1, v13
    v_lshlrev_b32 v14, 3, v14
    v_xor_b32 v14, v14, v152
    v_lshl_add_u32 v14, v14, 4, 64
    v_add_u32 v11, v12, v14
    v_add_u32 v0, 4294967280, v11
    s_mul_i32 s28, s3, 2176
    s_mul_i32 s38, s3, 2080
    s_mul_i32 s34, s3, 17408
    s_add_u32 s34, s34, 43520
    s_lshl_b32 s35, s2, 2
    s_add_u32 s35, s35, s3
    s_lshr_b32 s40, s35, 2
    s_and_b32 s40, s40, 3
    s_lshl_b32 s40, s40, 12
    s_lshl_b32 s35, s35, 14
    s_lshl_b32 s30, s2, 17
    s_sub_u32 s30, s30, 64
    s_subb_u32 s31, 0, 0
    s_sub_u32 s32, s35, 64
    s_subb_u32 s33, 0, 0
    s_mov_b32 s18, 131136
    s_mov_b32 s19, 0x20000
    s_mov_b32 s22, 131136
    s_mov_b32 s23, 0x20000
    s_mov_b32 s14, 16448
    s_mov_b32 s15, 0x20000
    s_mov_b32 s26, 16384
    s_mov_b32 s27, 0x20000
    s_lshr_b32 s64, s2, 0
    s_and_b32 s64, s64, 15
    s_lshl_b32 s64, s64, 13
    s_xor_b32 s65, s64, 8192
    s_waitcnt lgkmcnt(0)
    s_add_u32 m0, s28, 0
    s_add_u32 s16, s6, s30
    s_addc_u32 s17, s7, s31
    buffer_load_dwordx4 v6, s[16:19], s64 offen nt lds
    buffer_load_dwordx4 v7, s[16:19], s64 offen offset:1088 nt lds
    s_add_u32 m0, s28, 8704
    s_nop 0
    buffer_load_dwordx4 v6, s[16:19], s65 offen nt lds
    buffer_load_dwordx4 v7, s[16:19], s65 offen offset:1088 nt lds
    s_add_u32 m0, s38, 113152
    s_add_u32 s20, s8, s30
    s_addc_u32 s21, s9, s31
    buffer_load_dwordx4 v11, s[20:23], s64 offen nt lds
    buffer_load_dwordx4 v0, s[20:23], s64 offen offset:1040 nt lds
    s_add_u32 s12, s4, s32
    s_addc_u32 s13, s5, s33
    s_add_u32 s24, s10, s35
    s_addc_u32 s25, s11, 0
    s_xor_b32 s42, s40, 2048
    s_xor_b32 s44, s40, 4096
    s_xor_b32 s46, s40, 6144
    s_xor_b32 s48, s40, 8192
    s_xor_b32 s50, s40, 10240
    s_xor_b32 s52, s40, 12288
    s_xor_b32 s54, s40, 14336
    s_getreg_b32 s35, hwreg(HW_REG_XCC_ID, 0, 1)
    s_cmp_lg_u32 s35, 0
    s_cselect_b64 vcc, -1, 0
    s_cbranch_vccz L_j0
    s_add_u32 m0, s34, 0
    s_nop 0
    buffer_load_dwordx4 v156, s[12:15], s40 offen nt lds
    buffer_load_dwordx4 v157, s[12:15], s40 offen offset:1088 nt lds
    s_add_u32 m0, s34, 2176
    s_nop 0
    buffer_load_dwordx4 v156, s[12:15], s42 offen nt lds
    buffer_load_dwordx4 v157, s[12:15], s42 offen offset:1088 nt lds
L_j0:
    s_xor_b32 s66, s64, 16384
    s_xor_b32 s67, s64, 24576
    s_xor_b32 s68, s64, 32768
    s_xor_b32 s69, s64, 40960
    s_xor_b32 s70, s64, 49152
    s_xor_b32 s71, s64, 57344
    s_xor_b32 s72, s64, 65536
    s_xor_b32 s73, s64, 73728
    s_xor_b32 s74, s64, 81920
    s_xor_b32 s75, s64, 90112
    s_xor_b32 s76, s64, 98304
    s_xor_b32 s77, s64, 106496
    s_xor_b32 s78, s64, 114688
    s_xor_b32 s79, s64, 122880
    s_mov_b32 s30, 0x3e0293ee
    s_mov_b32 s31, 0x4f800000
    v_and_b32 v12, 3, v152
    v_bfe_u32 v13, v152, 2, 2
    v_lshrrev_b32 v14, 4, v152
    v_mul_u32_u24 v1, 1088, v12
    v_lshl_add_u32 v1, v13, 8, v1
    v_and_b32 v15, 2, v13
    v_xor_b32 v15, v15, v14
    v_lshl_add_u32 v1, v15, 4, v1
    v_add_u32 v153, s34, v1
    v_mul_u32_u24 v2, 1040, v13
    v_lshl_add_u32 v2, v14, 8, v2
    v_and_b32 v15, 1, v12
    v_lshl_add_u32 v2, v15, 3, v2
    v_lshrrev_b32 v15, 1, v12
    v_lshl_add_u32 v2, v15, 6, v2
    v_and_b32 v15, 1, v14
    v_lshl_add_u32 v2, v15, 7, v2
    v_xor_b32 v3, 128, v2
    v_add_u32 v4, 139264, v2
    v_add_u32 v5, 139264, v3
    v_add_u32 v2, 69632, v2
    v_add_u32 v3, 69632, v3
    s_mul_i32 s35, s3, 8704
    v_lshlrev_b32 v9, 8, v14
    v_lshl_add_u32 v9, v12, 6, v9
    v_lshl_add_u32 v9, v13, 3, v9
    v_lshl_add_u32 v9, v15, 5, v9
    v_add_u32 v9, s35, v9
    v_lshrrev_b32 v12, 5, v152
    v_lshlrev_b32 v13, 2, v12
    v_xor_b32 v13, v13, v152
    v_lshl_add_u32 v8, v13, 3, s35
    v_and_b32 v13, 7, v152
    v_lshlrev_b32 v13, 4, v13
    v_lshl_add_u32 v10, v12, 10, v13
    v_bfe_u32 v13, v152, 3, 2
    v_lshl_add_u32 v10, v13, 8, v10
    s_lshl_b32 s35, s3, 8
    s_add_u32 s35, s35, 156928
    v_lshl_add_u32 v12, v152, 2, s35
    v_lshl_add_u32 v13, v14, 4, s35
    v_xor_b32 v14, 32, v9
    v_mov_b32 v15, 0x3f803f80
    v_accvgpr_write_b32 a112, v15
    v_accvgpr_write_b32 a113, v15
    v_accvgpr_write_b32 a114, v15
    v_accvgpr_write_b32 a115, v15
    v_mov_b32 v16, 0xff800000
    v_mov_b32 v20, 0xff800000
    v_mov_b32 v24, 0xff800000
    v_mov_b32 v28, 0xff800000
    s_mov_b64 exec, 0
    s_cmp_eq_u32 s3, 0
    s_cbranch_scc1 L_pad0
    s_cmp_eq_u32 s3, 1
    s_cbranch_scc1 L_pad1
    s_cmp_eq_u32 s3, 2
    s_cbranch_scc1 L_pad2
    s_branch L_pad3
.p2align 12
L_main:
    s_mov_b64 exec, -1
    s_cbranch_vccnz L_o1
    s_waitcnt vmcnt(4)
    s_add_u32 m0, s34, 0
    s_nop 0
    buffer_load_dwordx4 v156, s[12:15], s40 offen nt lds
    buffer_load_dwordx4 v157, s[12:15], s40 offen offset:1088 nt lds
    s_waitcnt vmcnt(4)
    s_add_u32 m0, s34, 2176
    s_nop 0
    buffer_load_dwordx4 v156, s[12:15], s42 offen nt lds
    buffer_load_dwordx4 v157, s[12:15], s42 offen offset:1088 nt lds
    s_waitcnt vmcnt(4)
    s_add_u32 m0, s34, 4352
    s_nop 0
    buffer_load_dwordx4 v156, s[12:15], s44 offen nt lds
    buffer_load_dwordx4 v157, s[12:15], s44 offen offset:1088 nt lds
    s_branch L_j1
L_o1:
    s_waitcnt vmcnt(8)
    s_waitcnt vmcnt(6)
    s_waitcnt vmcnt(4)
    s_add_u32 m0, s34, 4352
    s_nop 0
    buffer_load_dwordx4 v156, s[12:15], s44 offen nt lds
    buffer_load_dwordx4 v157, s[12:15], s44 offen offset:1088 nt lds
L_j1:
    s_barrier
    ds_read_b128 a[116:119], v1 offset:0
    ds_read_b128 a[120:123], v1 offset:64
    ds_read_b128 a[124:127], v1 offset:128
    ds_read_b128 a[128:131], v1 offset:192
    ds_read_b128 a[144:147], v1 offset:4352
    ds_read_b128 a[140:143], v1 offset:4416
    ds_read_b128 a[136:139], v1 offset:4480
    ds_read_b128 a[132:135], v1 offset:4544
    ds_read_b128 a[148:151], v1 offset:8704
    ds_read_b128 a[152:155], v1 offset:8768
    ds_read_b128 a[156:159], v1 offset:8832
    ds_read_b128 a[160:163], v1 offset:8896
    ds_read_b128 a[176:179], v1 offset:13056
    ds_read_b128 a[172:175], v1 offset:13120
    ds_read_b128 a[168:171], v1 offset:13184
    ds_read_b128 a[164:167], v1 offset:13248
    ds_read_b64_tr_b16 a[180:181], v2 offset:43520
    ds_read_b64_tr_b16 a[182:183], v2 offset:47680
    ds_read_b64_tr_b16 a[184:185], v2 offset:43536
    ds_read_b64_tr_b16 a[186:187], v2 offset:47696
    ds_read_b64_tr_b16 a[188:189], v2 offset:43552
    ds_read_b64_tr_b16 a[190:191], v2 offset:47712
    ds_read_b64_tr_b16 a[192:193], v2 offset:43568
    ds_read_b64_tr_b16 a[194:195], v2 offset:47728
    ds_read_b64_tr_b16 a[196:197], v3 offset:43520
    ds_read_b64_tr_b16 a[198:199], v3 offset:47680
    ds_read_b64_tr_b16 a[200:201], v3 offset:43536
    ds_read_b64_tr_b16 a[202:203], v3 offset:47696
    ds_read_b64_tr_b16 a[204:205], v3 offset:43552
    ds_read_b64_tr_b16 a[206:207], v3 offset:47712
    ds_read_b64_tr_b16 a[208:209], v3 offset:43568
    ds_read_b64_tr_b16 a[210:211], v3 offset:47728
    s_cmp_lg_u32 s29, 0
    s_cbranch_scc1 L_maxpass
L_maxdone:
    s_waitcnt vmcnt(4)
    s_add_u32 m0, s34, 6528
    s_nop 0
    buffer_load_dwordx4 v156, s[12:15], s46 offen nt lds
    buffer_load_dwordx4 v157, s[12:15], s46 offen offset:1088 nt lds
    s_waitcnt vmcnt(4)
    ds_read_b128 v[128:131], v153 offset:0
    ds_read_b128 v[132:135], v153 offset:64
    ds_read_b128 v[136:139], v153 offset:128
    ds_read_b128 v[140:143], v153 offset:192
    s_add_u32 m0, s34, 8704
    s_nop 0
    buffer_load_dwordx4 v156, s[12:15], s48 offen nt lds
    buffer_load_dwordx4 v157, s[12:15], s48 offen offset:1088 nt lds
    s_waitcnt lgkmcnt(3)
    v_lshlrev_b32 v144, 16, v128
    v_and_b32 v145, 0xffff0000, v128
    v_lshlrev_b32 v146, 16, v129
    v_and_b32 v147, 0xffff0000, v129
    v_lshlrev_b32 v148, 16, v130
    v_and_b32 v149, 0xffff0000, v130
    v_lshlrev_b32 v150, 16, v131
    v_and_b32 v151, 0xffff0000, v131
    v_pk_mul_f32 v[144:145], v[144:145], s[30:31] op_sel_hi:[1,0]
    v_pk_mul_f32 v[146:147], v[146:147], s[30:31] op_sel_hi:[1,0]
    v_pk_mul_f32 v[148:149], v[148:149], s[30:31] op_sel_hi:[1,0]
    v_pk_mul_f32 v[150:151], v[150:151], s[30:31] op_sel_hi:[1,0]
    v_cvt_pk_bf16_f32 v144, v144, v145
    v_cvt_pk_bf16_f32 v146, v146, v147
    v_cvt_pk_bf16_f32 v148, v148, v149
    v_cvt_pk_bf16_f32 v150, v150, v151
    v_accvgpr_write_b32 a48, v144
    v_accvgpr_write_b32 a49, v146
    v_accvgpr_write_b32 a50, v148
    v_accvgpr_write_b32 a51, v150
    s_waitcnt lgkmcnt(2)
    v_lshlrev_b32 v144, 16, v132
    v_and_b32 v145, 0xffff0000, v132
    v_lshlrev_b32 v146, 16, v133
    v_and_b32 v147, 0xffff0000, v133
    v_lshlrev_b32 v148, 16, v134
    v_and_b32 v149, 0xffff0000, v134
    v_lshlrev_b32 v150, 16, v135
    v_and_b32 v151, 0xffff0000, v135
    v_pk_mul_f32 v[144:145], v[144:145], s[30:31] op_sel_hi:[1,0]
    v_pk_mul_f32 v[146:147], v[146:147], s[30:31] op_sel_hi:[1,0]
    v_pk_mul_f32 v[148:149], v[148:149], s[30:31] op_sel_hi:[1,0]
    v_pk_mul_f32 v[150:151], v[150:151], s[30:31] op_sel_hi:[1,0]
    v_cvt_pk_bf16_f32 v144, v144, v145
    v_cvt_pk_bf16_f32 v146, v146, v147
    v_cvt_pk_bf16_f32 v148, v148, v149
    v_cvt_pk_bf16_f32 v150, v150, v151
    v_accvgpr_write_b32 a52, v144
    v_accvgpr_write_b32 a53, v146
    v_accvgpr_write_b32 a54, v148
    v_accvgpr_write_b32 a55, v150
    s_waitcnt lgkmcnt(1)
    v_lshlrev_b32 v144, 16, v136
    v_and_b32 v145, 0xffff0000, v136
    v_lshlrev_b32 v146, 16, v137
    v_and_b32 v147, 0xffff0000, v137
    v_lshlrev_b32 v148, 16, v138
    v_and_b32 v149, 0xffff0000, v138
    v_lshlrev_b32 v150, 16, v139
    v_and_b32 v151, 0xffff0000, v139
    v_pk_mul_f32 v[144:145], v[144:145], s[30:31] op_sel_hi:[1,0]
    v_pk_mul_f32 v[146:147], v[146:147], s[30:31] op_sel_hi:[1,0]
    v_pk_mul_f32 v[148:149], v[148:149], s[30:31] op_sel_hi:[1,0]
    v_pk_mul_f32 v[150:151], v[150:151], s[30:31] op_sel_hi:[1,0]
    v_cvt_pk_bf16_f32 v144, v144, v145
    v_cvt_pk_bf16_f32 v146, v146, v147
    v_cvt_pk_bf16_f32 v148, v148, v149
    v_cvt_pk_bf16_f32 v150, v150, v151
    v_accvgpr_write_b32 a56, v144
    v_accvgpr_write_b32 a57, v146
    v_accvgpr_write_b32 a58, v148
    v_accvgpr_write_b32 a59, v150
    s_waitcnt lgkmcnt(0)
    v_lshlrev_b32 v144, 16, v140
    v_and_b32 v145, 0xffff0000, v140
    v_lshlrev_b32 v146, 16, v141
    v_and_b32 v147, 0xffff0000, v141
    v_lshlrev_b32 v148, 16, v142
    v_and_b32 v149, 0xffff0000, v142
    v_lshlrev_b32 v150, 16, v143
    v_and_b32 v151, 0xffff0000, v143
    v_pk_mul_f32 v[144:145], v[144:145], s[30:31] op_sel_hi:[1,0]
    v_pk_mul_f32 v[146:147], v[146:147], s[30:31] op_sel_hi:[1,0]
    v_pk_mul_f32 v[148:149], v[148:149], s[30:31] op_sel_hi:[1,0]
    v_pk_mul_f32 v[150:151], v[150:151], s[30:31] op_sel_hi:[1,0]
    v_cvt_pk_bf16_f32 v144, v144, v145
    v_cvt_pk_bf16_f32 v146, v146, v147
    v_cvt_pk_bf16_f32 v148, v148, v149
    v_cvt_pk_bf16_f32 v150, v150, v151
    v_accvgpr_write_b32 a60, v144
    v_accvgpr_write_b32 a61, v146
    v_accvgpr_write_b32 a62, v148
    v_accvgpr_write_b32 a63, v150
    s_add_u32 m0, s34, 10880
    s_nop 0
    buffer_load_dwordx4 v156, s[12:15], s50 offen nt lds
    buffer_load_dwordx4 v157, s[12:15], s50 offen offset:1088 nt lds
    v_mfma_f32_16x16x32_bf16 v[32:35], a[116:119], a[48:51], 0
    v_mfma_f32_16x16x32_bf16 v[32:35], a[120:123], a[52:55], v[32:35]
    v_mfma_f32_16x16x32_bf16 v[32:35], a[124:127], a[56:59], v[32:35]
    v_mfma_f32_16x16x32_bf16 v[32:35], a[128:131], a[60:63], v[32:35]
    s_nop 1
    v_mfma_f32_16x16x32_bf16 v[36:39], a[132:135], a[60:63], 0
    s_nop 1
    v_mfma_f32_16x16x32_bf16 v[36:39], a[136:139], a[56:59], v[36:39]
    s_nop 1
    v_mfma_f32_16x16x32_bf16 v[36:39], a[140:143], a[52:55], v[36:39]
    v_max3_f32 v16, v32, v33, v16
    v_max3_f32 v16, v34, v35, v16
    v_mfma_f32_16x16x32_bf16 v[36:39], a[144:147], a[48:51], v[36:39]
    v_mov_b32 v17, v16
    v_mfma_f32_16x16x32_bf16 v[40:43], a[148:151], a[48:51], 0
    s_nop 1
    v_mfma_f32_16x16x32_bf16 v[40:43], a[152:155], a[52:55], v[40:43]
    v_permlane32_swap_b32 v17, v16
    v_max_f32 v16, v16, v17
    v_mfma_f32_16x16x32_bf16 v[40:43], a[156:159], a[56:59], v[40:43]
    v_mov_b32 v17, v16
    s_nop 1
    v_permlane16_swap_b32 v17, v16
    v_max_f32 v16, v16, v17
    v_mul_f32 v17, -1.0, v16
    v_mul_f32 v18, -1.0, v16
    v_mul_f32 v19, -1.0, v16
    v_mul_f32 v16, -1.0, v16
    v_mfma_f32_16x16x32_bf16 v[40:43], a[160:163], a[60:63], v[40:43]
    v_add_f32 v32, v32, v17
    v_add_f32 v36, v36, v17
    v_mfma_f32_16x16x32_bf16 v[44:47], a[164:167], a[60:63], v[16:19]
    v_exp_f32 v32, v32
    v_mfma_f32_16x16x32_bf16 v[44:47], a[168:171], a[56:59], v[44:47]
    v_add_f32 v33, v33, v17
    v_add_f32 v37, v37, v17
    v_mfma_f32_16x16x32_bf16 v[44:47], a[172:175], a[52:55], v[44:47]
    v_exp_f32 v36, v36
    v_exp_f32 v33, v33
    v_add_f32 v34, v34, v17
    v_cvt_pk_bf16_f32 v52, v32, v33
    v_exp_f32 v37, v37
    v_add_f32 v38, v38, v17
    v_cvt_pk_bf16_f32 v54, v36, v37
    v_exp_f32 v34, v34
    v_add_f32 v35, v35, v17
    v_exp_f32 v38, v38
    v_add_f32 v39, v39, v17
    v_exp_f32 v35, v35
    v_exp_f32 v39, v39
    v_cvt_pk_bf16_f32 v53, v34, v35
    v_cvt_pk_bf16_f32 v55, v38, v39
    v_mfma_f32_16x16x32_bf16 v[44:47], a[176:179], a[48:51], v[44:47]
    v_add_f32 v40, v40, v17
    v_add_f32 v41, v41, v17
    v_mfma_f32_16x16x32_bf16 a[0:3], a[112:115], v[52:55], 0
    v_exp_f32 v40, v40
    v_mfma_f32_16x16x32_bf16 v[224:227], v[52:55], a[180:183], 0
    v_exp_f32 v41, v41
    v_mfma_f32_16x16x32_bf16 v[228:231], v[52:55], a[184:187], 0
    v_cvt_pk_bf16_f32 v56, v40, v41
    v_add_f32 v42, v42, v17
    v_mfma_f32_16x16x32_bf16 v[232:235], v[52:55], a[188:191], 0
    v_exp_f32 v42, v42
    v_mfma_f32_16x16x32_bf16 v[236:239], v[52:55], a[192:195], 0
    v_exp_f32 v44, v44
    v_mfma_f32_16x16x32_bf16 v[240:243], v[52:55], a[196:199], 0
    v_exp_f32 v45, v45
    v_mfma_f32_16x16x32_bf16 v[244:247], v[52:55], a[200:203], 0
    v_add_f32 v43, v43, v17
    v_cvt_pk_bf16_f32 v58, v44, v45
    v_mfma_f32_16x16x32_bf16 v[248:251], v[52:55], a[204:207], 0
    v_exp_f32 v43, v43
    v_mfma_f32_16x16x32_bf16 v[252:255], v[52:55], a[208:211], 0
    v_cvt_pk_bf16_f32 v57, v42, v43
    v_exp_f32 v46, v46
    v_exp_f32 v47, v47
    s_nop 0
    v_cvt_pk_bf16_f32 v59, v46, v47
    s_waitcnt vmcnt(4)
    ds_read_b128 v[128:131], v153 offset:4352
    ds_read_b128 v[132:135], v153 offset:4416
    ds_read_b128 v[136:139], v153 offset:4480
    ds_read_b128 v[140:143], v153 offset:4544
    s_add_u32 m0, s34, 13056
    s_nop 0
    buffer_load_dwordx4 v156, s[12:15], s52 offen nt lds
    buffer_load_dwordx4 v157, s[12:15], s52 offen offset:1088 nt lds
    s_waitcnt lgkmcnt(3)
    v_lshlrev_b32 v144, 16, v128
    v_and_b32 v145, 0xffff0000, v128
    v_lshlrev_b32 v146, 16, v129
    v_and_b32 v147, 0xffff0000, v129
    v_lshlrev_b32 v148, 16, v130
    v_and_b32 v149, 0xffff0000, v130
    v_lshlrev_b32 v150, 16, v131
    v_and_b32 v151, 0xffff0000, v131
    v_pk_mul_f32 v[144:145], v[144:145], s[30:31] op_sel_hi:[1,0]
    v_pk_mul_f32 v[146:147], v[146:147], s[30:31] op_sel_hi:[1,0]
    v_pk_mul_f32 v[148:149], v[148:149], s[30:31] op_sel_hi:[1,0]
    v_pk_mul_f32 v[150:151], v[150:151], s[30:31] op_sel_hi:[1,0]
    v_cvt_pk_bf16_f32 v144, v144, v145
    v_cvt_pk_bf16_f32 v146, v146, v147
    v_cvt_pk_bf16_f32 v148, v148, v149
    v_cvt_pk_bf16_f32 v150, v150, v151
    v_accvgpr_write_b32 a64, v144
    v_accvgpr_write_b32 a65, v146
    v_accvgpr_write_b32 a66, v148
    v_accvgpr_write_b32 a67, v150
    s_waitcnt lgkmcnt(2)
    v_lshlrev_b32 v144, 16, v132
    v_and_b32 v145, 0xffff0000, v132
    v_lshlrev_b32 v146, 16, v133
    v_and_b32 v147, 0xffff0000, v133
    v_lshlrev_b32 v148, 16, v134
    v_and_b32 v149, 0xffff0000, v134
    v_lshlrev_b32 v150, 16, v135
    v_and_b32 v151, 0xffff0000, v135
    v_pk_mul_f32 v[144:145], v[144:145], s[30:31] op_sel_hi:[1,0]
    v_pk_mul_f32 v[146:147], v[146:147], s[30:31] op_sel_hi:[1,0]
    v_pk_mul_f32 v[148:149], v[148:149], s[30:31] op_sel_hi:[1,0]
    v_pk_mul_f32 v[150:151], v[150:151], s[30:31] op_sel_hi:[1,0]
    v_cvt_pk_bf16_f32 v144, v144, v145
    v_cvt_pk_bf16_f32 v146, v146, v147
    v_cvt_pk_bf16_f32 v148, v148, v149
    v_cvt_pk_bf16_f32 v150, v150, v151
    v_accvgpr_write_b32 a68, v144
    v_accvgpr_write_b32 a69, v146
    v_accvgpr_write_b32 a70, v148
    v_accvgpr_write_b32 a71, v150
    s_waitcnt lgkmcnt(1)
    v_lshlrev_b32 v144, 16, v136
    v_and_b32 v145, 0xffff0000, v136
    v_lshlrev_b32 v146, 16, v137
    v_and_b32 v147, 0xffff0000, v137
    v_lshlrev_b32 v148, 16, v138
    v_and_b32 v149, 0xffff0000, v138
    v_lshlrev_b32 v150, 16, v139
    v_and_b32 v151, 0xffff0000, v139
    v_pk_mul_f32 v[144:145], v[144:145], s[30:31] op_sel_hi:[1,0]
    v_pk_mul_f32 v[146:147], v[146:147], s[30:31] op_sel_hi:[1,0]
    v_pk_mul_f32 v[148:149], v[148:149], s[30:31] op_sel_hi:[1,0]
    v_pk_mul_f32 v[150:151], v[150:151], s[30:31] op_sel_hi:[1,0]
    v_cvt_pk_bf16_f32 v144, v144, v145
    v_cvt_pk_bf16_f32 v146, v146, v147
    v_cvt_pk_bf16_f32 v148, v148, v149
    v_cvt_pk_bf16_f32 v150, v150, v151
    v_accvgpr_write_b32 a72, v144
    v_accvgpr_write_b32 a73, v146
    v_accvgpr_write_b32 a74, v148
    v_accvgpr_write_b32 a75, v150
    s_waitcnt lgkmcnt(0)
    v_lshlrev_b32 v144, 16, v140
    v_and_b32 v145, 0xffff0000, v140
    v_lshlrev_b32 v146, 16, v141
    v_and_b32 v147, 0xffff0000, v141
    v_lshlrev_b32 v148, 16, v142
    v_and_b32 v149, 0xffff0000, v142
    v_lshlrev_b32 v150, 16, v143
    v_and_b32 v151, 0xffff0000, v143
    v_pk_mul_f32 v[144:145], v[144:145], s[30:31] op_sel_hi:[1,0]
    v_pk_mul_f32 v[146:147], v[146:147], s[30:31] op_sel_hi:[1,0]
    v_pk_mul_f32 v[148:149], v[148:149], s[30:31] op_sel_hi:[1,0]
    v_pk_mul_f32 v[150:151], v[150:151], s[30:31] op_sel_hi:[1,0]
    v_cvt_pk_bf16_f32 v144, v144, v145
    v_cvt_pk_bf16_f32 v146, v146, v147
    v_cvt_pk_bf16_f32 v148, v148, v149
    v_cvt_pk_bf16_f32 v150, v150, v151
    v_accvgpr_write_b32 a76, v144
    v_accvgpr_write_b32 a77, v146
    v_accvgpr_write_b32 a78, v148
    v_accvgpr_write_b32 a79, v150
    s_add_u32 m0, s34, 15232
    s_nop 0
    buffer_load_dwordx4 v156, s[12:15], s54 offen nt lds
    buffer_load_dwordx4 v157, s[12:15], s54 offen offset:1088 nt lds
    v_mfma_f32_16x16x32_bf16 v[48:51], a[116:119], a[64:67], 0
    v_mfma_f32_16x16x32_bf16 v[48:51], a[120:123], a[68:71], v[48:51]
    v_mfma_f32_16x16x32_bf16 v[48:51], a[124:127], a[72:75], v[48:51]
    v_mfma_f32_16x16x32_bf16 v[48:51], a[128:131], a[76:79], v[48:51]
    s_nop 1
    v_mfma_f32_16x16x32_bf16 v[32:35], a[132:135], a[76:79], 0
    s_nop 1
    v_mfma_f32_16x16x32_bf16 v[32:35], a[136:139], a[72:75], v[32:35]
    s_nop 1
    v_mfma_f32_16x16x32_bf16 v[32:35], a[140:143], a[68:71], v[32:35]
    v_max3_f32 v20, v48, v49, v20
    v_max3_f32 v20, v50, v51, v20
    v_mfma_f32_16x16x32_bf16 v[32:35], a[144:147], a[64:67], v[32:35]
    v_mov_b32 v21, v20
    v_mfma_f32_16x16x32_bf16 v[36:39], a[148:151], a[64:67], 0
    s_nop 1
    v_mfma_f32_16x16x32_bf16 v[36:39], a[152:155], a[68:71], v[36:39]
    v_permlane32_swap_b32 v21, v20
    v_max_f32 v20, v20, v21
    v_mfma_f32_16x16x32_bf16 v[36:39], a[156:159], a[72:75], v[36:39]
    v_mov_b32 v21, v20
    s_nop 1
    v_permlane16_swap_b32 v21, v20
    v_max_f32 v20, v20, v21
    v_mul_f32 v21, -1.0, v20
    v_mul_f32 v22, -1.0, v20
    v_mul_f32 v23, -1.0, v20
    v_mul_f32 v20, -1.0, v20
    v_mfma_f32_16x16x32_bf16 v[36:39], a[160:163], a[76:79], v[36:39]
    v_add_f32 v48, v48, v21
    v_add_f32 v32, v32, v21
    v_mfma_f32_16x16x32_bf16 v[40:43], a[164:167], a[76:79], v[20:23]
    v_exp_f32 v48, v48
    v_mfma_f32_16x16x32_bf16 v[40:43], a[168:171], a[72:75], v[40:43]
    v_add_f32 v49, v49, v21
    v_add_f32 v33, v33, v21
    v_mfma_f32_16x16x32_bf16 v[40:43], a[172:175], a[68:71], v[40:43]
    v_exp_f32 v32, v32
    v_exp_f32 v49, v49
    v_add_f32 v50, v50, v21
    v_cvt_pk_bf16_f32 v60, v48, v49
    v_exp_f32 v33, v33
    v_add_f32 v34, v34, v21
    v_cvt_pk_bf16_f32 v62, v32, v33
    v_exp_f32 v50, v50
    v_add_f32 v51, v51, v21
    v_exp_f32 v34, v34
    v_add_f32 v35, v35, v21
    v_exp_f32 v51, v51
    v_exp_f32 v35, v35
    v_cvt_pk_bf16_f32 v61, v50, v51
    v_cvt_pk_bf16_f32 v63, v34, v35
    v_mfma_f32_16x16x32_bf16 v[40:43], a[176:179], a[64:67], v[40:43]
    v_add_f32 v36, v36, v21
    v_add_f32 v37, v37, v21
    v_mfma_f32_16x16x32_bf16 a[4:7], a[112:115], v[60:63], 0
    v_exp_f32 v36, v36
    v_mfma_f32_16x16x32_bf16 v[192:195], v[60:63], a[180:183], 0
    v_exp_f32 v37, v37
    v_mfma_f32_16x16x32_bf16 v[196:199], v[60:63], a[184:187], 0
    v_cvt_pk_bf16_f32 v64, v36, v37
    v_add_f32 v38, v38, v21
    v_mfma_f32_16x16x32_bf16 v[200:203], v[60:63], a[188:191], 0
    v_exp_f32 v38, v38
    v_mfma_f32_16x16x32_bf16 v[204:207], v[60:63], a[192:195], 0
    v_exp_f32 v40, v40
    v_mfma_f32_16x16x32_bf16 v[208:211], v[60:63], a[196:199], 0
    v_exp_f32 v41, v41
    v_mfma_f32_16x16x32_bf16 v[212:215], v[60:63], a[200:203], 0
    v_add_f32 v39, v39, v21
    v_cvt_pk_bf16_f32 v66, v40, v41
    v_mfma_f32_16x16x32_bf16 v[216:219], v[60:63], a[204:207], 0
    v_exp_f32 v39, v39
    v_mfma_f32_16x16x32_bf16 v[220:223], v[60:63], a[208:211], 0
    v_cvt_pk_bf16_f32 v65, v38, v39
    v_exp_f32 v42, v42
    v_exp_f32 v43, v43
    s_nop 0
    v_cvt_pk_bf16_f32 v67, v42, v43
    s_waitcnt vmcnt(4)
    ds_read_b128 v[128:131], v153 offset:8704
    ds_read_b128 v[132:135], v153 offset:8768
    ds_read_b128 v[136:139], v153 offset:8832
    ds_read_b128 v[140:143], v153 offset:8896
    s_add_u32 m0, s28, 17408
    s_nop 0
    buffer_load_dwordx4 v6, s[16:19], s66 offen nt lds
    buffer_load_dwordx4 v7, s[16:19], s66 offen offset:1088 nt lds
    s_waitcnt lgkmcnt(3)
    v_lshlrev_b32 v144, 16, v128
    v_and_b32 v145, 0xffff0000, v128
    v_lshlrev_b32 v146, 16, v129
    v_and_b32 v147, 0xffff0000, v129
    v_lshlrev_b32 v148, 16, v130
    v_and_b32 v149, 0xffff0000, v130
    v_lshlrev_b32 v150, 16, v131
    v_and_b32 v151, 0xffff0000, v131
    v_pk_mul_f32 v[144:145], v[144:145], s[30:31] op_sel_hi:[1,0]
    v_pk_mul_f32 v[146:147], v[146:147], s[30:31] op_sel_hi:[1,0]
    v_pk_mul_f32 v[148:149], v[148:149], s[30:31] op_sel_hi:[1,0]
    v_pk_mul_f32 v[150:151], v[150:151], s[30:31] op_sel_hi:[1,0]
    v_cvt_pk_bf16_f32 v144, v144, v145
    v_cvt_pk_bf16_f32 v146, v146, v147
    v_cvt_pk_bf16_f32 v148, v148, v149
    v_cvt_pk_bf16_f32 v150, v150, v151
    v_accvgpr_write_b32 a80, v144
    v_accvgpr_write_b32 a81, v146
    v_accvgpr_write_b32 a82, v148
    v_accvgpr_write_b32 a83, v150
    s_waitcnt lgkmcnt(2)
    v_lshlrev_b32 v144, 16, v132
    v_and_b32 v145, 0xffff0000, v132
    v_lshlrev_b32 v146, 16, v133
    v_and_b32 v147, 0xffff0000, v133
    v_lshlrev_b32 v148, 16, v134
    v_and_b32 v149, 0xffff0000, v134
    v_lshlrev_b32 v150, 16, v135
    v_and_b32 v151, 0xffff0000, v135
    v_pk_mul_f32 v[144:145], v[144:145], s[30:31] op_sel_hi:[1,0]
    v_pk_mul_f32 v[146:147], v[146:147], s[30:31] op_sel_hi:[1,0]
    v_pk_mul_f32 v[148:149], v[148:149], s[30:31] op_sel_hi:[1,0]
    v_pk_mul_f32 v[150:151], v[150:151], s[30:31] op_sel_hi:[1,0]
    v_cvt_pk_bf16_f32 v144, v144, v145
    v_cvt_pk_bf16_f32 v146, v146, v147
    v_cvt_pk_bf16_f32 v148, v148, v149
    v_cvt_pk_bf16_f32 v150, v150, v151
    v_accvgpr_write_b32 a84, v144
    v_accvgpr_write_b32 a85, v146
    v_accvgpr_write_b32 a86, v148
    v_accvgpr_write_b32 a87, v150
    s_waitcnt lgkmcnt(1)
    v_lshlrev_b32 v144, 16, v136
    v_and_b32 v145, 0xffff0000, v136
    v_lshlrev_b32 v146, 16, v137
    v_and_b32 v147, 0xffff0000, v137
    v_lshlrev_b32 v148, 16, v138
    v_and_b32 v149, 0xffff0000, v138
    v_lshlrev_b32 v150, 16, v139
    v_and_b32 v151, 0xffff0000, v139
    v_pk_mul_f32 v[144:145], v[144:145], s[30:31] op_sel_hi:[1,0]
    v_pk_mul_f32 v[146:147], v[146:147], s[30:31] op_sel_hi:[1,0]
    v_pk_mul_f32 v[148:149], v[148:149], s[30:31] op_sel_hi:[1,0]
    v_pk_mul_f32 v[150:151], v[150:151], s[30:31] op_sel_hi:[1,0]
    v_cvt_pk_bf16_f32 v144, v144, v145
    v_cvt_pk_bf16_f32 v146, v146, v147
    v_cvt_pk_bf16_f32 v148, v148, v149
    v_cvt_pk_bf16_f32 v150, v150, v151
    v_accvgpr_write_b32 a88, v144
    v_accvgpr_write_b32 a89, v146
    v_accvgpr_write_b32 a90, v148
    v_accvgpr_write_b32 a91, v150
    s_waitcnt lgkmcnt(0)
    v_lshlrev_b32 v144, 16, v140
    v_and_b32 v145, 0xffff0000, v140
    v_lshlrev_b32 v146, 16, v141
    v_and_b32 v147, 0xffff0000, v141
    v_lshlrev_b32 v148, 16, v142
    v_and_b32 v149, 0xffff0000, v142
    v_lshlrev_b32 v150, 16, v143
    v_and_b32 v151, 0xffff0000, v143
    v_pk_mul_f32 v[144:145], v[144:145], s[30:31] op_sel_hi:[1,0]
    v_pk_mul_f32 v[146:147], v[146:147], s[30:31] op_sel_hi:[1,0]
    v_pk_mul_f32 v[148:149], v[148:149], s[30:31] op_sel_hi:[1,0]
    v_pk_mul_f32 v[150:151], v[150:151], s[30:31] op_sel_hi:[1,0]
    v_cvt_pk_bf16_f32 v144, v144, v145
    v_cvt_pk_bf16_f32 v146, v146, v147
    v_cvt_pk_bf16_f32 v148, v148, v149
    v_cvt_pk_bf16_f32 v150, v150, v151
    v_accvgpr_write_b32 a92, v144
    v_accvgpr_write_b32 a93, v146
    v_accvgpr_write_b32 a94, v148
    v_accvgpr_write_b32 a95, v150
    s_add_u32 m0, s38, 121856
    s_nop 0
    buffer_load_dwordx4 v11, s[20:23], s65 offen nt lds
    buffer_load_dwordx4 v0, s[20:23], s65 offen offset:1040 nt lds
    v_mfma_f32_16x16x32_bf16 v[44:47], a[116:119], a[80:83], 0
    v_mfma_f32_16x16x32_bf16 v[44:47], a[120:123], a[84:87], v[44:47]
    v_mfma_f32_16x16x32_bf16 v[44:47], a[124:127], a[88:91], v[44:47]
    v_mfma_f32_16x16x32_bf16 v[44:47], a[128:131], a[92:95], v[44:47]
    s_nop 1
    v_mfma_f32_16x16x32_bf16 v[48:51], a[132:135], a[92:95], 0
    s_nop 1
    v_mfma_f32_16x16x32_bf16 v[48:51], a[136:139], a[88:91], v[48:51]
    s_nop 1
    v_mfma_f32_16x16x32_bf16 v[48:51], a[140:143], a[84:87], v[48:51]
    v_max3_f32 v24, v44, v45, v24
    v_max3_f32 v24, v46, v47, v24
    v_mfma_f32_16x16x32_bf16 v[48:51], a[144:147], a[80:83], v[48:51]
    v_mov_b32 v25, v24
    v_mfma_f32_16x16x32_bf16 v[32:35], a[148:151], a[80:83], 0
    s_nop 1
    v_mfma_f32_16x16x32_bf16 v[32:35], a[152:155], a[84:87], v[32:35]
    v_permlane32_swap_b32 v25, v24
    v_max_f32 v24, v24, v25
    v_mfma_f32_16x16x32_bf16 v[32:35], a[156:159], a[88:91], v[32:35]
    v_mov_b32 v25, v24
    s_nop 1
    v_permlane16_swap_b32 v25, v24
    v_max_f32 v24, v24, v25
    v_mul_f32 v25, -1.0, v24
    v_mul_f32 v26, -1.0, v24
    v_mul_f32 v27, -1.0, v24
    v_mul_f32 v24, -1.0, v24
    v_mfma_f32_16x16x32_bf16 v[32:35], a[160:163], a[92:95], v[32:35]
    v_add_f32 v44, v44, v25
    v_add_f32 v48, v48, v25
    v_mfma_f32_16x16x32_bf16 v[36:39], a[164:167], a[92:95], v[24:27]
    v_exp_f32 v44, v44
    v_mfma_f32_16x16x32_bf16 v[36:39], a[168:171], a[88:91], v[36:39]
    v_add_f32 v45, v45, v25
    v_add_f32 v49, v49, v25
    v_mfma_f32_16x16x32_bf16 v[36:39], a[172:175], a[84:87], v[36:39]
    v_exp_f32 v48, v48
    v_exp_f32 v45, v45
    v_add_f32 v46, v46, v25
    v_cvt_pk_bf16_f32 v68, v44, v45
    v_exp_f32 v49, v49
    v_add_f32 v50, v50, v25
    v_cvt_pk_bf16_f32 v70, v48, v49
    v_exp_f32 v46, v46
    v_add_f32 v47, v47, v25
    v_exp_f32 v50, v50
    v_add_f32 v51, v51, v25
    v_exp_f32 v47, v47
    v_exp_f32 v51, v51
    v_cvt_pk_bf16_f32 v69, v46, v47
    v_cvt_pk_bf16_f32 v71, v50, v51
    v_mfma_f32_16x16x32_bf16 v[36:39], a[176:179], a[80:83], v[36:39]
    v_add_f32 v32, v32, v25
    v_add_f32 v33, v33, v25
    v_mfma_f32_16x16x32_bf16 a[8:11], a[112:115], v[68:71], 0
    v_exp_f32 v32, v32
    v_mfma_f32_16x16x32_bf16 a[16:19], v[68:71], a[180:183], 0
    v_exp_f32 v33, v33
    v_mfma_f32_16x16x32_bf16 a[20:23], v[68:71], a[184:187], 0
    v_cvt_pk_bf16_f32 v72, v32, v33
    v_add_f32 v34, v34, v25
    v_mfma_f32_16x16x32_bf16 a[24:27], v[68:71], a[188:191], 0
    v_exp_f32 v34, v34
    v_mfma_f32_16x16x32_bf16 a[28:31], v[68:71], a[192:195], 0
    v_exp_f32 v36, v36
    v_mfma_f32_16x16x32_bf16 a[32:35], v[68:71], a[196:199], 0
    v_exp_f32 v37, v37
    v_mfma_f32_16x16x32_bf16 a[36:39], v[68:71], a[200:203], 0
    v_add_f32 v35, v35, v25
    v_cvt_pk_bf16_f32 v74, v36, v37
    v_mfma_f32_16x16x32_bf16 a[40:43], v[68:71], a[204:207], 0
    v_exp_f32 v35, v35
    v_mfma_f32_16x16x32_bf16 a[44:47], v[68:71], a[208:211], 0
    v_cvt_pk_bf16_f32 v73, v34, v35
    v_exp_f32 v38, v38
    v_exp_f32 v39, v39
    s_nop 0
    v_cvt_pk_bf16_f32 v75, v38, v39
    s_waitcnt vmcnt(4)
    ds_read_b128 v[128:131], v153 offset:13056
    ds_read_b128 v[132:135], v153 offset:13120
    ds_read_b128 v[136:139], v153 offset:13184
    ds_read_b128 v[140:143], v153 offset:13248
    s_add_u32 m0, s28, 26112
    s_nop 0
    buffer_load_dwordx4 v6, s[16:19], s67 offen nt lds
    buffer_load_dwordx4 v7, s[16:19], s67 offen offset:1088 nt lds
    s_waitcnt lgkmcnt(3)
    v_lshlrev_b32 v144, 16, v128
    v_and_b32 v145, 0xffff0000, v128
    v_lshlrev_b32 v146, 16, v129
    v_and_b32 v147, 0xffff0000, v129
    v_lshlrev_b32 v148, 16, v130
    v_and_b32 v149, 0xffff0000, v130
    v_lshlrev_b32 v150, 16, v131
    v_and_b32 v151, 0xffff0000, v131
    v_pk_mul_f32 v[144:145], v[144:145], s[30:31] op_sel_hi:[1,0]
    v_pk_mul_f32 v[146:147], v[146:147], s[30:31] op_sel_hi:[1,0]
    v_pk_mul_f32 v[148:149], v[148:149], s[30:31] op_sel_hi:[1,0]
    v_pk_mul_f32 v[150:151], v[150:151], s[30:31] op_sel_hi:[1,0]
    v_cvt_pk_bf16_f32 v144, v144, v145
    v_cvt_pk_bf16_f32 v146, v146, v147
    v_cvt_pk_bf16_f32 v148, v148, v149
    v_cvt_pk_bf16_f32 v150, v150, v151
    v_accvgpr_write_b32 a96, v144
    v_accvgpr_write_b32 a97, v146
    v_accvgpr_write_b32 a98, v148
    v_accvgpr_write_b32 a99, v150
    s_waitcnt lgkmcnt(2)
    v_lshlrev_b32 v144, 16, v132
    v_and_b32 v145, 0xffff0000, v132
    v_lshlrev_b32 v146, 16, v133
    v_and_b32 v147, 0xffff0000, v133
    v_lshlrev_b32 v148, 16, v134
    v_and_b32 v149, 0xffff0000, v134
    v_lshlrev_b32 v150, 16, v135
    v_and_b32 v151, 0xffff0000, v135
    v_pk_mul_f32 v[144:145], v[144:145], s[30:31] op_sel_hi:[1,0]
    v_pk_mul_f32 v[146:147], v[146:147], s[30:31] op_sel_hi:[1,0]
    v_pk_mul_f32 v[148:149], v[148:149], s[30:31] op_sel_hi:[1,0]
L_pad0:
    s_cbranch_execz L_pad4
    v_pk_mul_f32 v[150:151], v[150:151], s[30:31] op_sel_hi:[1,0]
    v_cvt_pk_bf16_f32 v144, v144, v145
    v_cvt_pk_bf16_f32 v146, v146, v147
    v_cvt_pk_bf16_f32 v148, v148, v149
    v_cvt_pk_bf16_f32 v150, v150, v151
    v_accvgpr_write_b32 a100, v144
    v_accvgpr_write_b32 a101, v146
    v_accvgpr_write_b32 a102, v148
    v_accvgpr_write_b32 a103, v150
    s_waitcnt lgkmcnt(1)
    v_lshlrev_b32 v144, 16, v136
    v_and_b32 v145, 0xffff0000, v136
    v_lshlrev_b32 v146, 16, v137
    v_and_b32 v147, 0xffff0000, v137
    v_lshlrev_b32 v148, 16, v138
    v_and_b32 v149, 0xffff0000, v138
    v_lshlrev_b32 v150, 16, v139
    v_and_b32 v151, 0xffff0000, v139
    v_pk_mul_f32 v[144:145], v[144:145], s[30:31] op_sel_hi:[1,0]
    v_pk_mul_f32 v[146:147], v[146:147], s[30:31] op_sel_hi:[1,0]
    v_pk_mul_f32 v[148:149], v[148:149], s[30:31] op_sel_hi:[1,0]
    v_pk_mul_f32 v[150:151], v[150:151], s[30:31] op_sel_hi:[1,0]
    v_cvt_pk_bf16_f32 v144, v144, v145
    v_cvt_pk_bf16_f32 v146, v146, v147
    v_cvt_pk_bf16_f32 v148, v148, v149
    v_cvt_pk_bf16_f32 v150, v150, v151
    v_accvgpr_write_b32 a104, v144
    v_accvgpr_write_b32 a105, v146
    v_accvgpr_write_b32 a106, v148
    v_accvgpr_write_b32 a107, v150
    s_waitcnt lgkmcnt(0)
    v_lshlrev_b32 v144, 16, v140
    v_and_b32 v145, 0xffff0000, v140
    v_lshlrev_b32 v146, 16, v141
    v_and_b32 v147, 0xffff0000, v141
    v_lshlrev_b32 v148, 16, v142
    v_and_b32 v149, 0xffff0000, v142
    v_lshlrev_b32 v150, 16, v143
    v_and_b32 v151, 0xffff0000, v143
    v_pk_mul_f32 v[144:145], v[144:145], s[30:31] op_sel_hi:[1,0]
    v_pk_mul_f32 v[146:147], v[146:147], s[30:31] op_sel_hi:[1,0]
    v_pk_mul_f32 v[148:149], v[148:149], s[30:31] op_sel_hi:[1,0]
    v_pk_mul_f32 v[150:151], v[150:151], s[30:31] op_sel_hi:[1,0]
    v_cvt_pk_bf16_f32 v144, v144, v145
    v_cvt_pk_bf16_f32 v146, v146, v147
    v_cvt_pk_bf16_f32 v148, v148, v149
    v_cvt_pk_bf16_f32 v150, v150, v151
    v_accvgpr_write_b32 a108, v144
    v_accvgpr_write_b32 a109, v146
    v_accvgpr_write_b32 a110, v148
    v_accvgpr_write_b32 a111, v150
    v_mfma_f32_16x16x32_bf16 v[40:43], a[116:119], a[96:99], 0
    v_mfma_f32_16x16x32_bf16 v[40:43], a[120:123], a[100:103], v[40:43]
    v_mfma_f32_16x16x32_bf16 v[40:43], a[124:127], a[104:107], v[40:43]
    v_mfma_f32_16x16x32_bf16 v[40:43], a[128:131], a[108:111], v[40:43]
    s_add_u32 m0, s28, 34816
    s_nop 1
    v_mfma_f32_16x16x32_bf16 v[44:47], a[132:135], a[108:111], 0
    buffer_load_dwordx4 v6, s[16:19], s68 offen nt lds
    buffer_load_dwordx4 v7, s[16:19], s68 offen offset:1088 nt lds
    v_mfma_f32_16x16x32_bf16 v[44:47], a[136:139], a[104:107], v[44:47]
    s_nop 1
    v_mfma_f32_16x16x32_bf16 v[44:47], a[140:143], a[100:103], v[44:47]
    v_max3_f32 v28, v40, v41, v28
    v_max3_f32 v28, v42, v43, v28
    v_mfma_f32_16x16x32_bf16 v[44:47], a[144:147], a[96:99], v[44:47]
    v_mov_b32 v29, v28
    v_mfma_f32_16x16x32_bf16 v[48:51], a[148:151], a[96:99], 0
    s_nop 1
    v_mfma_f32_16x16x32_bf16 v[48:51], a[152:155], a[100:103], v[48:51]
    v_permlane32_swap_b32 v29, v28
    v_max_f32 v28, v28, v29
    v_mfma_f32_16x16x32_bf16 v[48:51], a[156:159], a[104:107], v[48:51]
    v_mov_b32 v29, v28
    s_nop 1
    v_permlane16_swap_b32 v29, v28
    v_max_f32 v28, v28, v29
    v_mul_f32 v29, -1.0, v28
    v_mul_f32 v30, -1.0, v28
    v_mul_f32 v31, -1.0, v28
    v_mul_f32 v28, -1.0, v28
    v_mfma_f32_16x16x32_bf16 v[48:51], a[160:163], a[108:111], v[48:51]
    v_add_f32 v40, v40, v29
    v_add_f32 v44, v44, v29
    v_mfma_f32_16x16x32_bf16 v[32:35], a[164:167], a[108:111], v[28:31]
    v_exp_f32 v40, v40
    v_mfma_f32_16x16x32_bf16 v[32:35], a[168:171], a[104:107], v[32:35]
    v_add_f32 v41, v41, v29
    v_add_f32 v45, v45, v29
    v_mfma_f32_16x16x32_bf16 v[32:35], a[172:175], a[100:103], v[32:35]
    v_exp_f32 v44, v44
    v_exp_f32 v41, v41
    v_add_f32 v42, v42, v29
    v_cvt_pk_bf16_f32 v76, v40, v41
    v_exp_f32 v45, v45
    v_add_f32 v46, v46, v29
    v_cvt_pk_bf16_f32 v78, v44, v45
    v_exp_f32 v42, v42
    v_add_f32 v43, v43, v29
    v_exp_f32 v46, v46
    v_add_f32 v47, v47, v29
    v_exp_f32 v43, v43
    v_exp_f32 v47, v47
    v_cvt_pk_bf16_f32 v77, v42, v43
    v_cvt_pk_bf16_f32 v79, v46, v47
    v_mfma_f32_16x16x32_bf16 v[32:35], a[176:179], a[96:99], v[32:35]
    s_waitcnt vmcnt(6)
    s_barrier
    ds_read_b128 a[212:215], v1 offset:17408
    ds_read_b128 a[216:219], v1 offset:17472
    v_mfma_f32_16x16x32_bf16 a[12:15], a[112:115], v[76:79], 0
    ds_read_b128 a[220:223], v1 offset:17536
    ds_read_b128 a[224:227], v1 offset:17600
    v_mfma_f32_16x16x32_bf16 v[160:163], v[76:79], a[180:183], 0
    ds_read_b128 a[228:231], v1 offset:21760
    ds_read_b128 a[232:235], v1 offset:21824
    v_mfma_f32_16x16x32_bf16 v[164:167], v[76:79], a[184:187], 0
    ds_read_b128 a[236:239], v1 offset:21888
    v_add_f32 v48, v48, v29
    v_mfma_f32_16x16x32_bf16 v[168:171], v[76:79], a[188:191], 0
    v_exp_f32 v48, v48
    v_mfma_f32_16x16x32_bf16 v[172:175], v[76:79], a[192:195], 0
    ds_read_b128 a[240:243], v1 offset:21952
    v_add_f32 v49, v49, v29
    v_mfma_f32_16x16x32_bf16 v[176:179], v[76:79], a[196:199], 0
    v_exp_f32 v49, v49
    v_mfma_f32_16x16x32_bf16 v[180:183], v[76:79], a[200:203], 0
    v_cvt_pk_bf16_f32 v80, v48, v49
    v_add_f32 v50, v50, v29
    v_mfma_f32_16x16x32_bf16 v[184:187], v[76:79], a[204:207], 0
    v_exp_f32 v50, v50
    v_mfma_f32_16x16x32_bf16 v[188:191], v[76:79], a[208:211], 0
    s_waitcnt lgkmcnt(1)
    v_exp_f32 v32, v32
    v_mfma_f32_16x16x32_bf16 v[36:39], a[212:215], a[48:51], v[16:19]
    v_exp_f32 v33, v33
    v_mfma_f32_16x16x32_bf16 v[36:39], a[216:219], a[52:55], v[36:39]
    v_add_f32 v51, v51, v29
    v_cvt_pk_bf16_f32 v82, v32, v33
    v_mfma_f32_16x16x32_bf16 v[36:39], a[220:223], a[56:59], v[36:39]
    v_exp_f32 v51, v51
    v_mfma_f32_16x16x32_bf16 v[36:39], a[224:227], a[60:63], v[36:39]
    v_exp_f32 v34, v34
    v_mfma_f32_16x16x32_bf16 v[40:43], a[224:227], a[76:79], v[20:23]
    v_exp_f32 v35, v35
    v_mfma_f32_16x16x32_bf16 v[40:43], a[220:223], a[72:75], v[40:43]
    v_cvt_pk_bf16_f32 v81, v50, v51
    v_cvt_pk_bf16_f32 v83, v34, v35
    v_mfma_f32_16x16x32_bf16 v[40:43], a[216:219], a[68:71], v[40:43]
    s_nop 1
    v_mfma_f32_16x16x32_bf16 v[40:43], a[212:215], a[64:67], v[40:43]
    s_add_u32 m0, s38, 130560
    v_exp_f32 v36, v36
    v_mfma_f32_16x16x32_bf16 v[44:47], a[212:215], a[80:83], v[24:27]
    buffer_load_dwordx4 v11, s[20:23], s66 offen nt lds
    buffer_load_dwordx4 v0, s[20:23], s66 offen offset:1040 nt lds
    v_mfma_f32_16x16x32_bf16 v[44:47], a[216:219], a[84:87], v[44:47]
    v_exp_f32 v37, v37
    v_mfma_f32_16x16x32_bf16 v[44:47], a[220:223], a[88:91], v[44:47]
    v_exp_f32 v38, v38
    v_mfma_f32_16x16x32_bf16 v[44:47], a[224:227], a[92:95], v[44:47]
    v_exp_f32 v39, v39
    v_mfma_f32_16x16x32_bf16 v[48:51], a[224:227], a[108:111], v[28:31]
    v_cvt_pk_bf16_f32 v84, v36, v37
    v_cvt_pk_bf16_f32 v85, v38, v39
    v_mfma_f32_16x16x32_bf16 v[48:51], a[220:223], a[104:107], v[48:51]
    v_exp_f32 v40, v40
    v_mfma_f32_16x16x32_bf16 v[48:51], a[216:219], a[100:103], v[48:51]
    s_waitcnt vmcnt(6)
    s_barrier
    ds_read_b64_tr_b16 a[244:245], v2 offset:52224
    ds_read_b64_tr_b16 a[246:247], v2 offset:56384
    v_mfma_f32_16x16x32_bf16 v[48:51], a[212:215], a[96:99], v[48:51]
    ds_read_b64_tr_b16 a[248:249], v2 offset:52240
    ds_read_b64_tr_b16 a[250:251], v2 offset:56400
    v_mfma_f32_16x16x32_bf16 a[0:3], a[112:115], v[56:59], a[0:3]
    v_exp_f32 v41, v41
    v_mfma_f32_16x16x32_bf16 a[4:7], a[112:115], v[64:67], a[4:7]
    ds_read_b64_tr_b16 a[128:129], v2 offset:52256
    v_cvt_pk_bf16_f32 v88, v40, v41
    v_mfma_f32_16x16x32_bf16 a[8:11], a[112:115], v[72:75], a[8:11]
    v_exp_f32 v42, v42
    v_mfma_f32_16x16x32_bf16 v[32:35], a[228:231], a[48:51], v[16:19]
    v_exp_f32 v43, v43
    v_mfma_f32_16x16x32_bf16 v[32:35], a[232:235], a[52:55], v[32:35]
    ds_read_b64_tr_b16 a[130:131], v2 offset:56416
    v_cvt_pk_bf16_f32 v89, v42, v43
    v_mfma_f32_16x16x32_bf16 v[32:35], a[236:239], a[56:59], v[32:35]
    s_waitcnt lgkmcnt(2)
    v_exp_f32 v44, v44
    v_mfma_f32_16x16x32_bf16 v[32:35], a[240:243], a[60:63], v[32:35]
    v_exp_f32 v45, v45
    v_mfma_f32_16x16x32_bf16 a[12:15], a[112:115], v[80:83], a[12:15]
    ds_read_b64_tr_b16 a[132:133], v2 offset:52272
    v_cvt_pk_bf16_f32 v92, v44, v45
    v_mfma_f32_16x16x32_bf16 v[224:227], v[56:59], a[244:247], v[224:227]
    v_exp_f32 v46, v46
    v_mfma_f32_16x16x32_bf16 v[36:39], a[228:231], a[64:67], v[20:23]
    v_exp_f32 v47, v47
    v_mfma_f32_16x16x32_bf16 v[36:39], a[232:235], a[68:71], v[36:39]
    ds_read_b64_tr_b16 a[134:135], v2 offset:56432
    v_cvt_pk_bf16_f32 v93, v46, v47
    v_mfma_f32_16x16x32_bf16 v[36:39], a[236:239], a[72:75], v[36:39]
    v_exp_f32 v48, v48
    v_mfma_f32_16x16x32_bf16 v[36:39], a[240:243], a[76:79], v[36:39]
    s_waitcnt vmcnt(4)
    s_barrier
    ds_read_b128 a[252:255], v1 offset:26112
    ds_read_b128 a[116:119], v1 offset:26176
    v_mfma_f32_16x16x32_bf16 v[192:195], v[64:67], a[244:247], v[192:195]
    ds_read_b128 a[120:123], v1 offset:26240
    ds_read_b128 a[124:127], v1 offset:26304
    v_mfma_f32_16x16x32_bf16 a[16:19], v[72:75], a[244:247], a[16:19]
    v_exp_f32 v49, v49
    v_mfma_f32_16x16x32_bf16 v[40:43], a[228:231], a[80:83], v[24:27]
    ds_read_b64_tr_b16 a[136:137], v3 offset:52224
    v_cvt_pk_bf16_f32 v96, v48, v49
    v_mfma_f32_16x16x32_bf16 v[40:43], a[232:235], a[84:87], v[40:43]
    v_exp_f32 v50, v50
    v_mfma_f32_16x16x32_bf16 v[40:43], a[236:239], a[88:91], v[40:43]
    v_exp_f32 v51, v51
    v_mfma_f32_16x16x32_bf16 v[40:43], a[240:243], a[92:95], v[40:43]
    ds_read_b64_tr_b16 a[138:139], v3 offset:56384
    v_cvt_pk_bf16_f32 v97, v50, v51
    v_mfma_f32_16x16x32_bf16 v[160:163], v[80:83], a[244:247], v[160:163]
    v_exp_f32 v32, v32
    v_mfma_f32_16x16x32_bf16 v[228:231], v[56:59], a[248:251], v[228:231]
    s_add_u32 m0, s38, 139264
    v_exp_f32 v33, v33
    v_mfma_f32_16x16x32_bf16 v[44:47], a[228:231], a[96:99], v[28:31]
    buffer_load_dwordx4 v11, s[20:23], s67 offen nt lds
    buffer_load_dwordx4 v0, s[20:23], s67 offen offset:1040 nt lds
    v_mfma_f32_16x16x32_bf16 v[44:47], a[232:235], a[100:103], v[44:47]
    ds_read_b128 a[140:143], v1 offset:30464
    v_cvt_pk_bf16_f32 v86, v32, v33
    v_mfma_f32_16x16x32_bf16 v[44:47], a[236:239], a[104:107], v[44:47]
    v_exp_f32 v34, v34
    v_mfma_f32_16x16x32_bf16 v[44:47], a[240:243], a[108:111], v[44:47]
    v_exp_f32 v35, v35
    v_mfma_f32_16x16x32_bf16 v[196:199], v[64:67], a[248:251], v[196:199]
    ds_read_b128 a[144:147], v1 offset:30528
    v_cvt_pk_bf16_f32 v87, v34, v35
    v_mfma_f32_16x16x32_bf16 a[20:23], v[72:75], a[248:251], a[20:23]
    v_exp_f32 v36, v36
    v_mfma_f32_16x16x32_bf16 v[164:167], v[80:83], a[248:251], v[164:167]
    s_waitcnt lgkmcnt(2)
    v_exp_f32 v37, v37
    v_mfma_f32_16x16x32_bf16 v[48:51], a[252:255], a[48:51], v[16:19]
    ds_read_b128 a[148:151], v1 offset:30592
    v_cvt_pk_bf16_f32 v90, v36, v37
    v_mfma_f32_16x16x32_bf16 v[48:51], a[116:119], a[52:55], v[48:51]
    v_exp_f32 v38, v38
    v_mfma_f32_16x16x32_bf16 v[48:51], a[120:123], a[56:59], v[48:51]
    v_exp_f32 v39, v39
    v_mfma_f32_16x16x32_bf16 v[48:51], a[124:127], a[60:63], v[48:51]
    ds_read_b128 a[152:155], v1 offset:30656
    v_cvt_pk_bf16_f32 v91, v38, v39
    v_mfma_f32_16x16x32_bf16 v[232:235], v[56:59], a[128:131], v[232:235]
    v_exp_f32 v40, v40
    v_mfma_f32_16x16x32_bf16 v[200:203], v[64:67], a[128:131], v[200:203]
    v_exp_f32 v41, v41
    v_mfma_f32_16x16x32_bf16 v[32:35], a[252:255], a[64:67], v[20:23]
    ds_read_b64_tr_b16 a[156:157], v3 offset:52240
    v_cvt_pk_bf16_f32 v94, v40, v41
    v_mfma_f32_16x16x32_bf16 v[32:35], a[116:119], a[68:71], v[32:35]
    v_exp_f32 v42, v42
    v_mfma_f32_16x16x32_bf16 v[32:35], a[120:123], a[72:75], v[32:35]
    v_exp_f32 v43, v43
    v_mfma_f32_16x16x32_bf16 v[32:35], a[124:127], a[76:79], v[32:35]
    ds_read_b64_tr_b16 a[158:159], v3 offset:56400
    v_cvt_pk_bf16_f32 v95, v42, v43
    v_mfma_f32_16x16x32_bf16 a[24:27], v[72:75], a[128:131], a[24:27]
    v_exp_f32 v44, v44
    v_mfma_f32_16x16x32_bf16 v[168:171], v[80:83], a[128:131], v[168:171]
    v_exp_f32 v45, v45
    v_mfma_f32_16x16x32_bf16 v[36:39], a[252:255], a[80:83], v[24:27]
    ds_read_b64_tr_b16 a[160:161], v3 offset:52256
    v_cvt_pk_bf16_f32 v98, v44, v45
    v_mfma_f32_16x16x32_bf16 v[36:39], a[116:119], a[84:87], v[36:39]
    v_exp_f32 v46, v46
    v_mfma_f32_16x16x32_bf16 v[36:39], a[120:123], a[88:91], v[36:39]
    v_exp_f32 v47, v47
    v_mfma_f32_16x16x32_bf16 v[36:39], a[124:127], a[92:95], v[36:39]
    ds_read_b64_tr_b16 a[162:163], v3 offset:56416
    v_cvt_pk_bf16_f32 v99, v46, v47
    v_mfma_f32_16x16x32_bf16 v[236:239], v[56:59], a[132:135], v[236:239]
    v_exp_f32 v48, v48
    v_mfma_f32_16x16x32_bf16 v[204:207], v[64:67], a[132:135], v[204:207]
    v_exp_f32 v49, v49
    v_mfma_f32_16x16x32_bf16 v[40:43], a[252:255], a[96:99], v[28:31]
    ds_read_b64_tr_b16 a[180:181], v3 offset:52272
    v_cvt_pk_bf16_f32 v100, v48, v49
    v_mfma_f32_16x16x32_bf16 v[40:43], a[116:119], a[100:103], v[40:43]
    v_exp_f32 v50, v50
    v_mfma_f32_16x16x32_bf16 v[40:43], a[120:123], a[104:107], v[40:43]
    v_exp_f32 v51, v51
    v_mfma_f32_16x16x32_bf16 v[40:43], a[124:127], a[108:111], v[40:43]
    s_add_u32 m0, s28, 43520
    ds_read_b64_tr_b16 a[182:183], v3 offset:56432
    v_cvt_pk_bf16_f32 v101, v50, v51
    v_mfma_f32_16x16x32_bf16 a[28:31], v[72:75], a[132:135], a[28:31]
    buffer_load_dwordx4 v6, s[16:19], s69 offen nt lds
    buffer_load_dwordx4 v7, s[16:19], s69 offen offset:1088 nt lds
    v_mfma_f32_16x16x32_bf16 v[172:175], v[80:83], a[132:135], v[172:175]
    v_exp_f32 v32, v32
    v_mfma_f32_16x16x32_bf16 v[240:243], v[56:59], a[136:139], v[240:243]
    s_waitcnt lgkmcnt(1)
    v_exp_f32 v33, v33
    v_mfma_f32_16x16x32_bf16 v[44:47], a[140:143], a[48:51], v[16:19]
    v_exp_f32 v34, v34
    v_mfma_f32_16x16x32_bf16 v[44:47], a[144:147], a[52:55], v[44:47]
    v_exp_f32 v35, v35
    v_mfma_f32_16x16x32_bf16 v[44:47], a[148:151], a[56:59], v[44:47]
    v_cvt_pk_bf16_f32 v104, v32, v33
    v_cvt_pk_bf16_f32 v105, v34, v35
    v_mfma_f32_16x16x32_bf16 v[44:47], a[152:155], a[60:63], v[44:47]
    v_exp_f32 v36, v36
    v_mfma_f32_16x16x32_bf16 v[208:211], v[64:67], a[136:139], v[208:211]
    v_exp_f32 v37, v37
    v_mfma_f32_16x16x32_bf16 a[32:35], v[72:75], a[136:139], a[32:35]
    v_exp_f32 v38, v38
    v_mfma_f32_16x16x32_bf16 v[48:51], a[140:143], a[64:67], v[20:23]
    v_exp_f32 v39, v39
    v_mfma_f32_16x16x32_bf16 v[48:51], a[144:147], a[68:71], v[48:51]
    v_cvt_pk_bf16_f32 v108, v36, v37
    v_cvt_pk_bf16_f32 v109, v38, v39
    v_mfma_f32_16x16x32_bf16 v[48:51], a[148:151], a[72:75], v[48:51]
    v_exp_f32 v40, v40
    v_mfma_f32_16x16x32_bf16 v[48:51], a[152:155], a[76:79], v[48:51]
    s_waitcnt vmcnt(2)
    s_barrier
    ds_read_b128 a[164:167], v1 offset:34816
    ds_read_b128 a[168:171], v1 offset:34880
    v_mfma_f32_16x16x32_bf16 v[176:179], v[80:83], a[136:139], v[176:179]
    ds_read_b128 a[172:175], v1 offset:34944
    ds_read_b128 a[176:179], v1 offset:35008
    v_mfma_f32_16x16x32_bf16 v[244:247], v[56:59], a[156:159], v[244:247]
    v_exp_f32 v41, v41
    v_mfma_f32_16x16x32_bf16 v[32:35], a[140:143], a[80:83], v[24:27]
    ds_read_b128 a[184:187], v1 offset:39168
    v_cvt_pk_bf16_f32 v112, v40, v41
    v_mfma_f32_16x16x32_bf16 v[32:35], a[144:147], a[84:87], v[32:35]
    v_exp_f32 v42, v42
    v_mfma_f32_16x16x32_bf16 v[32:35], a[148:151], a[88:91], v[32:35]
    v_exp_f32 v43, v43
    v_mfma_f32_16x16x32_bf16 v[32:35], a[152:155], a[92:95], v[32:35]
    ds_read_b128 a[188:191], v1 offset:39232
    v_cvt_pk_bf16_f32 v113, v42, v43
    v_mfma_f32_16x16x32_bf16 v[212:215], v[64:67], a[156:159], v[212:215]
    v_exp_f32 v44, v44
    v_mfma_f32_16x16x32_bf16 a[36:39], v[72:75], a[156:159], a[36:39]
    v_exp_f32 v45, v45
    v_mfma_f32_16x16x32_bf16 v[36:39], a[140:143], a[96:99], v[28:31]
    ds_read_b128 a[192:195], v1 offset:39296
    v_cvt_pk_bf16_f32 v102, v44, v45
    v_mfma_f32_16x16x32_bf16 v[36:39], a[144:147], a[100:103], v[36:39]
    v_exp_f32 v46, v46
    v_mfma_f32_16x16x32_bf16 v[36:39], a[148:151], a[104:107], v[36:39]
    v_exp_f32 v47, v47
    v_mfma_f32_16x16x32_bf16 v[36:39], a[152:155], a[108:111], v[36:39]
    ds_read_b128 a[196:199], v1 offset:39360
    v_cvt_pk_bf16_f32 v103, v46, v47
    v_mfma_f32_16x16x32_bf16 v[180:183], v[80:83], a[156:159], v[180:183]
    v_exp_f32 v48, v48
    v_mfma_f32_16x16x32_bf16 v[248:251], v[56:59], a[160:163], v[248:251]
    v_exp_f32 v49, v49
    v_mfma_f32_16x16x32_bf16 v[216:219], v[64:67], a[160:163], v[216:219]
    s_waitcnt lgkmcnt(1)
    ds_read_b64_tr_b16 a[200:201], v2 offset:60928
    v_cvt_pk_bf16_f32 v106, v48, v49
    v_mfma_f32_16x16x32_bf16 v[40:43], a[164:167], a[48:51], v[16:19]
    s_add_u32 m0, s28, 52224
    v_exp_f32 v50, v50
    v_mfma_f32_16x16x32_bf16 v[40:43], a[168:171], a[52:55], v[40:43]
    buffer_load_dwordx4 v6, s[16:19], s70 offen nt lds
    buffer_load_dwordx4 v7, s[16:19], s70 offen offset:1088 nt lds
    v_mfma_f32_16x16x32_bf16 v[40:43], a[172:175], a[56:59], v[40:43]
    v_exp_f32 v51, v51
    v_mfma_f32_16x16x32_bf16 v[40:43], a[176:179], a[60:63], v[40:43]
    ds_read_b64_tr_b16 a[202:203], v2 offset:65088
    v_cvt_pk_bf16_f32 v107, v50, v51
    v_mfma_f32_16x16x32_bf16 a[40:43], v[72:75], a[160:163], a[40:43]
    v_exp_f32 v32, v32
    v_mfma_f32_16x16x32_bf16 v[184:187], v[80:83], a[160:163], v[184:187]
    v_exp_f32 v33, v33
    v_mfma_f32_16x16x32_bf16 v[44:47], a[164:167], a[64:67], v[20:23]
    ds_read_b64_tr_b16 a[204:205], v4 offset:0
    v_cvt_pk_bf16_f32 v110, v32, v33
    v_mfma_f32_16x16x32_bf16 v[44:47], a[168:171], a[68:71], v[44:47]
    v_exp_f32 v34, v34
    v_mfma_f32_16x16x32_bf16 v[44:47], a[172:175], a[72:75], v[44:47]
    v_exp_f32 v35, v35
    v_mfma_f32_16x16x32_bf16 v[44:47], a[176:179], a[76:79], v[44:47]
    ds_read_b64_tr_b16 a[206:207], v4 offset:4160
    v_cvt_pk_bf16_f32 v111, v34, v35
    v_mfma_f32_16x16x32_bf16 v[252:255], v[56:59], a[180:183], v[252:255]
    v_exp_f32 v36, v36
    v_mfma_f32_16x16x32_bf16 v[220:223], v[64:67], a[180:183], v[220:223]
    v_exp_f32 v37, v37
    v_mfma_f32_16x16x32_bf16 v[48:51], a[164:167], a[80:83], v[24:27]
    ds_read_b64_tr_b16 a[208:209], v4 offset:16
    v_cvt_pk_bf16_f32 v114, v36, v37
    v_mfma_f32_16x16x32_bf16 v[48:51], a[168:171], a[84:87], v[48:51]
    v_exp_f32 v38, v38
    v_mfma_f32_16x16x32_bf16 v[48:51], a[172:175], a[88:91], v[48:51]
    v_exp_f32 v39, v39
    v_mfma_f32_16x16x32_bf16 v[48:51], a[176:179], a[92:95], v[48:51]
    ds_read_b64_tr_b16 a[210:211], v4 offset:4176
    v_cvt_pk_bf16_f32 v115, v38, v39
    v_mfma_f32_16x16x32_bf16 a[44:47], v[72:75], a[180:183], a[44:47]
    v_exp_f32 v40, v40
    v_mfma_f32_16x16x32_bf16 v[188:191], v[80:83], a[180:183], v[188:191]
    v_exp_f32 v41, v41
    v_mfma_f32_16x16x32_bf16 v[32:35], a[164:167], a[96:99], v[28:31]
    ds_read_b64_tr_b16 a[224:225], v2 offset:60944
    v_cvt_pk_bf16_f32 v116, v40, v41
    v_mfma_f32_16x16x32_bf16 v[32:35], a[168:171], a[100:103], v[32:35]
    v_exp_f32 v42, v42
    v_mfma_f32_16x16x32_bf16 v[32:35], a[172:175], a[104:107], v[32:35]
    v_exp_f32 v43, v43
    v_mfma_f32_16x16x32_bf16 v[32:35], a[176:179], a[108:111], v[32:35]
    ds_read_b64_tr_b16 a[226:227], v2 offset:65104
    v_cvt_pk_bf16_f32 v117, v42, v43
    v_mfma_f32_16x16x32_bf16 a[0:3], a[112:115], v[84:87], a[0:3]
    v_exp_f32 v44, v44
    v_mfma_f32_16x16x32_bf16 a[0:3], a[112:115], v[100:103], a[0:3]
    v_exp_f32 v45, v45
    v_mfma_f32_16x16x32_bf16 a[4:7], a[112:115], v[104:107], a[4:7]
    ds_read_b64_tr_b16 a[228:229], v2 offset:60960
    v_cvt_pk_bf16_f32 v120, v44, v45
    v_mfma_f32_16x16x32_bf16 a[4:7], a[112:115], v[88:91], a[4:7]
    v_exp_f32 v46, v46
    v_mfma_f32_16x16x32_bf16 a[8:11], a[112:115], v[92:95], a[8:11]
    v_exp_f32 v47, v47
    v_mfma_f32_16x16x32_bf16 a[8:11], a[112:115], v[108:111], a[8:11]
    ds_read_b64_tr_b16 a[230:231], v2 offset:65120
    v_cvt_pk_bf16_f32 v121, v46, v47
    v_mfma_f32_16x16x32_bf16 v[36:39], a[184:187], a[48:51], v[16:19]
    v_exp_f32 v48, v48
    v_mfma_f32_16x16x32_bf16 v[36:39], a[188:191], a[52:55], v[36:39]
    s_add_u32 m0, s38, 147968
    v_exp_f32 v49, v49
    v_mfma_f32_16x16x32_bf16 v[36:39], a[192:195], a[56:59], v[36:39]
    s_waitcnt lgkmcnt(1)
    buffer_load_dwordx4 v11, s[20:23], s68 offen nt lds
    buffer_load_dwordx4 v0, s[20:23], s68 offen offset:1040 nt lds
    v_mfma_f32_16x16x32_bf16 v[36:39], a[196:199], a[60:63], v[36:39]
    ds_read_b64_tr_b16 a[232:233], v4 offset:32
    v_cvt_pk_bf16_f32 v124, v48, v49
    v_mfma_f32_16x16x32_bf16 a[12:15], a[112:115], v[96:99], a[12:15]
    v_exp_f32 v50, v50
    v_mfma_f32_16x16x32_bf16 a[12:15], a[112:115], v[112:115], a[12:15]
    v_exp_f32 v51, v51
    v_mfma_f32_16x16x32_bf16 v[224:227], v[84:87], a[200:203], v[224:227]
    ds_read_b64_tr_b16 a[234:235], v4 offset:4192
    v_cvt_pk_bf16_f32 v125, v50, v51
    v_mfma_f32_16x16x32_bf16 v[224:227], v[100:103], a[204:207], v[224:227]
    v_exp_f32 v32, v32
    v_mfma_f32_16x16x32_bf16 v[40:43], a[184:187], a[64:67], v[20:23]
    v_exp_f32 v33, v33
    v_mfma_f32_16x16x32_bf16 v[40:43], a[188:191], a[68:71], v[40:43]
    ds_read_b64_tr_b16 a[236:237], v2 offset:60976
    v_cvt_pk_bf16_f32 v52, v32, v33
    v_mfma_f32_16x16x32_bf16 v[40:43], a[192:195], a[72:75], v[40:43]
    v_exp_f32 v34, v34
    v_mfma_f32_16x16x32_bf16 v[40:43], a[196:199], a[76:79], v[40:43]
    v_exp_f32 v35, v35
    v_mfma_f32_16x16x32_bf16 v[192:195], v[88:91], a[200:203], v[192:195]
    ds_read_b64_tr_b16 a[238:239], v2 offset:65136
    v_cvt_pk_bf16_f32 v53, v34, v35
    v_mfma_f32_16x16x32_bf16 v[192:195], v[104:107], a[204:207], v[192:195]
    v_exp_f32 v36, v36
    v_mfma_f32_16x16x32_bf16 a[16:19], v[108:111], a[204:207], a[16:19]
    v_exp_f32 v37, v37
    v_mfma_f32_16x16x32_bf16 a[16:19], v[92:95], a[200:203], a[16:19]
    ds_read_b64_tr_b16 a[240:241], v4 offset:48
    v_cvt_pk_bf16_f32 v118, v36, v37
    v_mfma_f32_16x16x32_bf16 v[44:47], a[184:187], a[80:83], v[24:27]
    v_exp_f32 v38, v38
    v_mfma_f32_16x16x32_bf16 v[44:47], a[188:191], a[84:87], v[44:47]
    v_exp_f32 v39, v39
    v_mfma_f32_16x16x32_bf16 v[44:47], a[192:195], a[88:91], v[44:47]
    s_waitcnt vmcnt(4)
    s_barrier
    ds_read_b128 a[220:223], v1 offset:43520
    ds_read_b128 a[216:219], v1 offset:43584
    v_mfma_f32_16x16x32_bf16 v[44:47], a[196:199], a[92:95], v[44:47]
    ds_read_b128 a[212:215], v1 offset:43648
    ds_read_b128 a[244:247], v1 offset:43712
    v_mfma_f32_16x16x32_bf16 v[160:163], v[96:99], a[200:203], v[160:163]
    ds_read_b64_tr_b16 a[242:243], v4 offset:4208
    v_cvt_pk_bf16_f32 v119, v38, v39
    v_mfma_f32_16x16x32_bf16 v[160:163], v[112:115], a[204:207], v[160:163]
    v_exp_f32 v40, v40
    v_mfma_f32_16x16x32_bf16 v[228:231], v[100:103], a[208:211], v[228:231]
    v_exp_f32 v41, v41
    v_mfma_f32_16x16x32_bf16 v[228:231], v[84:87], a[224:227], v[228:231]
    ds_read_b64_tr_b16 a[248:249], v3 offset:60928
    v_cvt_pk_bf16_f32 v122, v40, v41
    v_mfma_f32_16x16x32_bf16 v[48:51], a[184:187], a[96:99], v[28:31]
    v_exp_f32 v42, v42
    v_mfma_f32_16x16x32_bf16 v[48:51], a[188:191], a[100:103], v[48:51]
    v_exp_f32 v43, v43
    v_mfma_f32_16x16x32_bf16 v[48:51], a[192:195], a[104:107], v[48:51]
    ds_read_b64_tr_b16 a[250:251], v3 offset:65088
    v_cvt_pk_bf16_f32 v123, v42, v43
    v_mfma_f32_16x16x32_bf16 v[48:51], a[196:199], a[108:111], v[48:51]
    ds_read_b64_tr_b16 a[128:129], v5 offset:0
    ds_read_b64_tr_b16 a[130:131], v5 offset:4160
    v_mfma_f32_16x16x32_bf16 v[196:199], v[88:91], a[224:227], v[196:199]
    v_exp_f32 v44, v44
    v_mfma_f32_16x16x32_bf16 v[196:199], v[104:107], a[208:211], v[196:199]
    ds_read_b128 a[252:255], v1 offset:47872
    ds_read_b128 a[116:119], v1 offset:47936
    v_mfma_f32_16x16x32_bf16 a[20:23], v[108:111], a[208:211], a[20:23]
    v_exp_f32 v45, v45
    v_mfma_f32_16x16x32_bf16 a[20:23], v[92:95], a[224:227], a[20:23]
    ds_read_b128 a[120:123], v1 offset:48000
    v_cvt_pk_bf16_f32 v126, v44, v45
    v_mfma_f32_16x16x32_bf16 v[164:167], v[96:99], a[224:227], v[164:167]
    v_exp_f32 v46, v46
    v_mfma_f32_16x16x32_bf16 v[164:167], v[112:115], a[208:211], v[164:167]
    s_waitcnt lgkmcnt(3)
    v_exp_f32 v47, v47
    v_mfma_f32_16x16x32_bf16 v[32:35], a[220:223], a[48:51], v[16:19]
    s_add_u32 m0, s38, 69632
    ds_read_b128 a[124:127], v1 offset:48064
    v_cvt_pk_bf16_f32 v127, v46, v47
    v_mfma_f32_16x16x32_bf16 v[32:35], a[216:219], a[52:55], v[32:35]
    buffer_load_dwordx4 v11, s[20:23], s69 offen nt lds
    buffer_load_dwordx4 v0, s[20:23], s69 offen offset:1040 nt lds
    v_mfma_f32_16x16x32_bf16 v[32:35], a[212:215], a[56:59], v[32:35]
    v_exp_f32 v48, v48
    v_mfma_f32_16x16x32_bf16 v[32:35], a[244:247], a[60:63], v[32:35]
    v_exp_f32 v49, v49
    v_mfma_f32_16x16x32_bf16 v[232:235], v[84:87], a[228:231], v[232:235]
    ds_read_b64_tr_b16 a[132:133], v5 offset:16
    v_cvt_pk_bf16_f32 v54, v48, v49
    v_mfma_f32_16x16x32_bf16 v[232:235], v[100:103], a[232:235], v[232:235]
    v_exp_f32 v50, v50
    v_mfma_f32_16x16x32_bf16 v[200:203], v[104:107], a[232:235], v[200:203]
    v_exp_f32 v51, v51
    v_mfma_f32_16x16x32_bf16 v[200:203], v[88:91], a[228:231], v[200:203]
    ds_read_b64_tr_b16 a[134:135], v5 offset:4176
    v_cvt_pk_bf16_f32 v55, v50, v51
    v_mfma_f32_16x16x32_bf16 v[36:39], a[220:223], a[64:67], v[20:23]
    ds_read_b64_tr_b16 a[136:137], v3 offset:60944
    ds_read_b64_tr_b16 a[138:139], v3 offset:65104
    v_mfma_f32_16x16x32_bf16 v[36:39], a[216:219], a[68:71], v[36:39]
    v_exp_f32 v32, v32
    v_mfma_f32_16x16x32_bf16 v[36:39], a[212:215], a[72:75], v[36:39]
    v_exp_f32 v33, v33
    v_mfma_f32_16x16x32_bf16 v[36:39], a[244:247], a[76:79], v[36:39]
    ds_read_b64_tr_b16 a[140:141], v5 offset:32
    v_cvt_pk_bf16_f32 v60, v32, v33
    v_mfma_f32_16x16x32_bf16 a[24:27], v[92:95], a[228:231], a[24:27]
    v_exp_f32 v34, v34
    v_mfma_f32_16x16x32_bf16 a[24:27], v[108:111], a[232:235], a[24:27]
    v_exp_f32 v35, v35
    v_mfma_f32_16x16x32_bf16 v[168:171], v[112:115], a[232:235], v[168:171]
    ds_read_b64_tr_b16 a[142:143], v5 offset:4192
    v_cvt_pk_bf16_f32 v61, v34, v35
    v_mfma_f32_16x16x32_bf16 v[168:171], v[96:99], a[228:231], v[168:171]
    v_exp_f32 v36, v36
    v_mfma_f32_16x16x32_bf16 v[40:43], a[220:223], a[80:83], v[24:27]
    v_exp_f32 v37, v37
    v_mfma_f32_16x16x32_bf16 v[40:43], a[216:219], a[84:87], v[40:43]
    ds_read_b64_tr_b16 a[144:145], v3 offset:60960
    v_cvt_pk_bf16_f32 v68, v36, v37
    v_mfma_f32_16x16x32_bf16 v[40:43], a[212:215], a[88:91], v[40:43]
    v_exp_f32 v38, v38
    v_mfma_f32_16x16x32_bf16 v[40:43], a[244:247], a[92:95], v[40:43]
    v_exp_f32 v39, v39
    v_mfma_f32_16x16x32_bf16 v[236:239], v[84:87], a[236:239], v[236:239]
    ds_read_b64_tr_b16 a[146:147], v3 offset:65120
    v_cvt_pk_bf16_f32 v69, v38, v39
    v_mfma_f32_16x16x32_bf16 v[236:239], v[100:103], a[240:243], v[236:239]
    ds_read_b64_tr_b16 a[180:181], v3 offset:60976
    ds_read_b64_tr_b16 a[182:183], v3 offset:65136
    v_mfma_f32_16x16x32_bf16 v[204:207], v[104:107], a[240:243], v[204:207]
    v_exp_f32 v40, v40
    v_mfma_f32_16x16x32_bf16 v[204:207], v[88:91], a[236:239], v[204:207]
    v_exp_f32 v41, v41
    v_mfma_f32_16x16x32_bf16 v[44:47], a[220:223], a[96:99], v[28:31]
    ds_read_b64_tr_b16 a[164:165], v5 offset:48
    v_cvt_pk_bf16_f32 v128, v40, v41
    v_mfma_f32_16x16x32_bf16 v[44:47], a[216:219], a[100:103], v[44:47]
    v_exp_f32 v42, v42
    v_mfma_f32_16x16x32_bf16 v[44:47], a[212:215], a[104:107], v[44:47]
    v_exp_f32 v43, v43
    v_mfma_f32_16x16x32_bf16 v[44:47], a[244:247], a[108:111], v[44:47]
    ds_read_b64_tr_b16 a[166:167], v5 offset:4208
    v_cvt_pk_bf16_f32 v129, v42, v43
    v_mfma_f32_16x16x32_bf16 a[28:31], v[92:95], a[236:239], a[28:31]
    s_nop 1
    v_mfma_f32_16x16x32_bf16 a[28:31], v[108:111], a[240:243], a[28:31]
    s_nop 1
    v_mfma_f32_16x16x32_bf16 v[172:175], v[112:115], a[240:243], v[172:175]
L_pad1:
    s_cbranch_execz L_main
    v_exp_f32 v44, v44
    v_mfma_f32_16x16x32_bf16 v[172:175], v[96:99], a[236:239], v[172:175]
    v_exp_f32 v45, v45
    v_mfma_f32_16x16x32_bf16 v[240:243], v[84:87], a[248:251], v[240:243]
    v_exp_f32 v46, v46
    v_mfma_f32_16x16x32_bf16 v[240:243], v[100:103], a[128:131], v[240:243]
    s_waitcnt lgkmcnt(0)
    v_exp_f32 v47, v47
    v_mfma_f32_16x16x32_bf16 v[48:51], a[252:255], a[48:51], v[16:19]
    s_add_u32 m0, s28, 60928
    v_cvt_pk_bf16_f32 v132, v44, v45
    v_cvt_pk_bf16_f32 v133, v46, v47
    v_mfma_f32_16x16x32_bf16 v[48:51], a[116:119], a[52:55], v[48:51]
    buffer_load_dwordx4 v6, s[16:19], s71 offen nt lds
    buffer_load_dwordx4 v7, s[16:19], s71 offen offset:1088 nt lds
    v_mfma_f32_16x16x32_bf16 v[48:51], a[120:123], a[56:59], v[48:51]
    v_mfma_f32_16x16x32_bf16 v[48:51], a[124:127], a[60:63], v[48:51]
    s_nop 1
    v_mfma_f32_16x16x32_bf16 v[208:211], v[88:91], a[248:251], v[208:211]
    s_nop 1
    v_mfma_f32_16x16x32_bf16 v[208:211], v[104:107], a[128:131], v[208:211]
    s_nop 1
    v_mfma_f32_16x16x32_bf16 a[32:35], v[108:111], a[128:131], a[32:35]
    v_exp_f32 v48, v48
    v_mfma_f32_16x16x32_bf16 a[32:35], v[92:95], a[248:251], a[32:35]
    v_exp_f32 v49, v49
    v_mfma_f32_16x16x32_bf16 v[32:35], a[252:255], a[64:67], v[20:23]
    v_exp_f32 v50, v50
    v_mfma_f32_16x16x32_bf16 v[32:35], a[116:119], a[68:71], v[32:35]
    v_exp_f32 v51, v51
    v_mfma_f32_16x16x32_bf16 v[32:35], a[120:123], a[72:75], v[32:35]
    v_cvt_pk_bf16_f32 v62, v48, v49
    v_cvt_pk_bf16_f32 v63, v50, v51
    v_mfma_f32_16x16x32_bf16 v[32:35], a[124:127], a[76:79], v[32:35]
    s_nop 1
    v_mfma_f32_16x16x32_bf16 v[176:179], v[96:99], a[248:251], v[176:179]
    s_nop 1
    v_mfma_f32_16x16x32_bf16 v[176:179], v[112:115], a[128:131], v[176:179]
    s_nop 1
    v_mfma_f32_16x16x32_bf16 v[244:247], v[100:103], a[132:135], v[244:247]
    v_exp_f32 v32, v32
    v_mfma_f32_16x16x32_bf16 v[244:247], v[84:87], a[136:139], v[244:247]
    v_exp_f32 v33, v33
    v_mfma_f32_16x16x32_bf16 v[36:39], a[252:255], a[80:83], v[24:27]
    v_exp_f32 v34, v34
    v_mfma_f32_16x16x32_bf16 v[36:39], a[116:119], a[84:87], v[36:39]
    v_exp_f32 v35, v35
    v_mfma_f32_16x16x32_bf16 v[36:39], a[120:123], a[88:91], v[36:39]
    s_waitcnt vmcnt(6)
    s_barrier
    ds_read_b128 a[148:151], v1 offset:52224
    ds_read_b128 a[152:155], v1 offset:52288
    v_mfma_f32_16x16x32_bf16 v[36:39], a[124:127], a[92:95], v[36:39]
    ds_read_b128 a[156:159], v1 offset:52352
    ds_read_b128 a[160:163], v1 offset:52416
    v_mfma_f32_16x16x32_bf16 v[212:215], v[88:91], a[136:139], v[212:215]
    v_cvt_pk_bf16_f32 v70, v32, v33
    v_cvt_pk_bf16_f32 v71, v34, v35
    v_mfma_f32_16x16x32_bf16 v[212:215], v[104:107], a[132:135], v[212:215]
    ds_read_b128 a[168:171], v1 offset:56576
    ds_read_b128 a[172:175], v1 offset:56640
    v_mfma_f32_16x16x32_bf16 a[36:39], v[108:111], a[132:135], a[36:39]
    v_exp_f32 v36, v36
    v_mfma_f32_16x16x32_bf16 a[36:39], v[92:95], a[136:139], a[36:39]
    v_exp_f32 v37, v37
    v_mfma_f32_16x16x32_bf16 v[40:43], a[252:255], a[96:99], v[28:31]
    ds_read_b128 a[176:179], v1 offset:56704
    v_cvt_pk_bf16_f32 v130, v36, v37
    v_mfma_f32_16x16x32_bf16 v[40:43], a[116:119], a[100:103], v[40:43]
    v_exp_f32 v38, v38
    v_mfma_f32_16x16x32_bf16 v[40:43], a[120:123], a[104:107], v[40:43]
    v_exp_f32 v39, v39
    v_mfma_f32_16x16x32_bf16 v[40:43], a[124:127], a[108:111], v[40:43]
    ds_read_b128 a[200:203], v1 offset:56768
    v_cvt_pk_bf16_f32 v131, v38, v39
    v_mfma_f32_16x16x32_bf16 v[180:183], v[96:99], a[136:139], v[180:183]
    s_add_u32 m0, s28, 0
    s_nop 1
    v_mfma_f32_16x16x32_bf16 v[180:183], v[112:115], a[132:135], v[180:183]
    buffer_load_dwordx4 v6, s[16:19], s72 offen nt lds
    buffer_load_dwordx4 v7, s[16:19], s72 offen offset:1088 nt lds
    v_mfma_f32_16x16x32_bf16 v[248:251], v[100:103], a[140:143], v[248:251]
    v_exp_f32 v40, v40
    v_mfma_f32_16x16x32_bf16 v[248:251], v[84:87], a[144:147], v[248:251]
    v_exp_f32 v41, v41
    v_mfma_f32_16x16x32_bf16 v[216:219], v[88:91], a[144:147], v[216:219]
    v_exp_f32 v42, v42
    v_mfma_f32_16x16x32_bf16 v[216:219], v[104:107], a[140:143], v[216:219]
    s_waitcnt lgkmcnt(0)
    v_exp_f32 v43, v43
    v_mfma_f32_16x16x32_bf16 v[44:47], a[148:151], a[48:51], v[16:19]
    v_cvt_pk_bf16_f32 v134, v40, v41
    v_cvt_pk_bf16_f32 v135, v42, v43
    v_mfma_f32_16x16x32_bf16 v[44:47], a[152:155], a[52:55], v[44:47]
    v_mfma_f32_16x16x32_bf16 v[44:47], a[156:159], a[56:59], v[44:47]
    v_mfma_f32_16x16x32_bf16 v[44:47], a[160:163], a[60:63], v[44:47]
    s_nop 1
    v_mfma_f32_16x16x32_bf16 a[40:43], v[92:95], a[144:147], a[40:43]
    s_nop 1
    v_mfma_f32_16x16x32_bf16 a[40:43], v[108:111], a[140:143], a[40:43]
    s_nop 1
    v_mfma_f32_16x16x32_bf16 v[184:187], v[112:115], a[140:143], v[184:187]
    v_exp_f32 v44, v44
    v_mfma_f32_16x16x32_bf16 v[184:187], v[96:99], a[144:147], v[184:187]
    v_exp_f32 v45, v45
    v_mfma_f32_16x16x32_bf16 v[48:51], a[148:151], a[64:67], v[20:23]
    v_exp_f32 v46, v46
    v_mfma_f32_16x16x32_bf16 v[48:51], a[152:155], a[68:71], v[48:51]
    v_exp_f32 v47, v47
    v_mfma_f32_16x16x32_bf16 v[48:51], a[156:159], a[72:75], v[48:51]
    v_cvt_pk_bf16_f32 v136, v44, v45
    v_cvt_pk_bf16_f32 v137, v46, v47
    v_mfma_f32_16x16x32_bf16 v[48:51], a[160:163], a[76:79], v[48:51]
    s_nop 1
    v_mfma_f32_16x16x32_bf16 v[252:255], v[84:87], a[180:183], v[252:255]
    s_nop 1
    v_mfma_f32_16x16x32_bf16 v[252:255], v[100:103], a[164:167], v[252:255]
    s_nop 1
    v_mfma_f32_16x16x32_bf16 v[220:223], v[104:107], a[164:167], v[220:223]
    v_exp_f32 v48, v48
    v_mfma_f32_16x16x32_bf16 v[220:223], v[88:91], a[180:183], v[220:223]
    v_exp_f32 v49, v49
    v_mfma_f32_16x16x32_bf16 v[32:35], a[148:151], a[80:83], v[24:27]
    v_exp_f32 v50, v50
    v_mfma_f32_16x16x32_bf16 v[32:35], a[152:155], a[84:87], v[32:35]
    v_exp_f32 v51, v51
    v_mfma_f32_16x16x32_bf16 v[32:35], a[156:159], a[88:91], v[32:35]
    v_cvt_pk_bf16_f32 v140, v48, v49
    v_cvt_pk_bf16_f32 v141, v50, v51
    v_mfma_f32_16x16x32_bf16 v[32:35], a[160:163], a[92:95], v[32:35]
    s_nop 1
    v_mfma_f32_16x16x32_bf16 a[44:47], v[92:95], a[180:183], a[44:47]
    s_nop 1
    v_mfma_f32_16x16x32_bf16 a[44:47], v[108:111], a[164:167], a[44:47]
    s_nop 1
    v_mfma_f32_16x16x32_bf16 v[188:191], v[112:115], a[164:167], v[188:191]
    v_exp_f32 v32, v32
    v_mfma_f32_16x16x32_bf16 v[188:191], v[96:99], a[180:183], v[188:191]
    s_add_u32 m0, s38, 78336
    v_exp_f32 v33, v33
    v_mfma_f32_16x16x32_bf16 v[36:39], a[148:151], a[96:99], v[28:31]
    s_waitcnt vmcnt(2)
    s_barrier
    buffer_load_dwordx4 v11, s[20:23], s70 offen nt lds
    buffer_load_dwordx4 v0, s[20:23], s70 offen offset:1040 nt lds
    v_mfma_f32_16x16x32_bf16 v[36:39], a[152:155], a[100:103], v[36:39]
    ds_read_b64_tr_b16 a[204:205], v4 offset:8704
    ds_read_b64_tr_b16 a[206:207], v4 offset:12864
    v_mfma_f32_16x16x32_bf16 v[36:39], a[156:159], a[104:107], v[36:39]
    ds_read_b64_tr_b16 a[184:185], v2 offset:0
    ds_read_b64_tr_b16 a[186:187], v2 offset:4160
    v_mfma_f32_16x16x32_bf16 v[36:39], a[160:163], a[108:111], v[36:39]
    ds_read_b64_tr_b16 a[188:189], v2 offset:16
    ds_read_b64_tr_b16 a[190:191], v2 offset:4176
    v_mfma_f32_16x16x32_bf16 a[0:3], a[112:115], v[116:119], a[0:3]
    ds_read_b64_tr_b16 a[192:193], v4 offset:8720
    ds_read_b64_tr_b16 a[194:195], v4 offset:12880
    v_mfma_f32_16x16x32_bf16 a[0:3], a[112:115], v[60:63], a[0:3]
    ds_read_b128 a[196:199], v1 offset:60928
    v_cvt_pk_bf16_f32 v144, v32, v33
    v_mfma_f32_16x16x32_bf16 a[4:7], a[112:115], v[68:71], a[4:7]
    ds_read_b128 a[224:227], v1 offset:60992
    ds_read_b128 a[208:211], v1 offset:61056
    v_mfma_f32_16x16x32_bf16 a[4:7], a[112:115], v[120:123], a[4:7]
    v_exp_f32 v34, v34
    v_mfma_f32_16x16x32_bf16 a[8:11], a[112:115], v[124:127], a[8:11]
    v_exp_f32 v35, v35
    v_mfma_f32_16x16x32_bf16 a[8:11], a[112:115], v[128:131], a[8:11]
    ds_read_b128 a[232:235], v1 offset:61120
    v_cvt_pk_bf16_f32 v145, v34, v35
    v_mfma_f32_16x16x32_bf16 v[40:43], a[168:171], a[48:51], v[16:19]
    ds_read_b64_tr_b16 a[228:229], v4 offset:8736
    ds_read_b64_tr_b16 a[230:231], v4 offset:12896
    v_mfma_f32_16x16x32_bf16 v[40:43], a[172:175], a[52:55], v[40:43]
    ds_read_b64_tr_b16 a[220:221], v2 offset:32
    ds_read_b64_tr_b16 a[222:223], v2 offset:4192
    v_mfma_f32_16x16x32_bf16 v[40:43], a[176:179], a[56:59], v[40:43]
    v_exp_f32 v36, v36
    v_mfma_f32_16x16x32_bf16 v[40:43], a[200:203], a[60:63], v[40:43]
    v_exp_f32 v37, v37
    v_mfma_f32_16x16x32_bf16 a[12:15], a[112:115], v[52:55], a[12:15]
    ds_read_b64_tr_b16 a[216:217], v4 offset:8752
    v_cvt_pk_bf16_f32 v148, v36, v37
    v_mfma_f32_16x16x32_bf16 a[12:15], a[112:115], v[132:135], a[12:15]
    s_waitcnt lgkmcnt(5)
    v_exp_f32 v38, v38
    v_mfma_f32_16x16x32_bf16 v[224:227], v[116:119], a[204:207], v[224:227]
    v_exp_f32 v39, v39
    v_mfma_f32_16x16x32_bf16 v[224:227], v[60:63], a[184:187], v[224:227]
    ds_read_b64_tr_b16 a[218:219], v4 offset:12912
    v_cvt_pk_bf16_f32 v149, v38, v39
    v_mfma_f32_16x16x32_bf16 v[44:47], a[168:171], a[64:67], v[20:23]
    v_exp_f32 v40, v40
    v_mfma_f32_16x16x32_bf16 v[44:47], a[172:175], a[68:71], v[44:47]
    v_exp_f32 v41, v41
    v_mfma_f32_16x16x32_bf16 v[44:47], a[176:179], a[72:75], v[44:47]
    ds_read_b64_tr_b16 a[212:213], v2 offset:48
    v_cvt_pk_bf16_f32 v138, v40, v41
    v_mfma_f32_16x16x32_bf16 v[44:47], a[200:203], a[76:79], v[44:47]
    v_exp_f32 v42, v42
    v_mfma_f32_16x16x32_bf16 v[192:195], v[120:123], a[204:207], v[192:195]
    v_exp_f32 v43, v43
    v_mfma_f32_16x16x32_bf16 v[192:195], v[68:71], a[184:187], v[192:195]
    ds_read_b64_tr_b16 a[214:215], v2 offset:4208
    v_cvt_pk_bf16_f32 v139, v42, v43
    v_mfma_f32_16x16x32_bf16 a[16:19], v[128:131], a[184:187], a[16:19]
    ds_read_b64_tr_b16 a[244:245], v5 offset:8704
    ds_read_b64_tr_b16 a[246:247], v5 offset:12864
    v_mfma_f32_16x16x32_bf16 a[16:19], v[124:127], a[204:207], a[16:19]
    v_exp_f32 v44, v44
    v_mfma_f32_16x16x32_bf16 v[48:51], a[168:171], a[80:83], v[24:27]
    v_exp_f32 v45, v45
    v_mfma_f32_16x16x32_bf16 v[48:51], a[172:175], a[84:87], v[48:51]
    ds_read_b64_tr_b16 a[240:241], v3 offset:0
    v_cvt_pk_bf16_f32 v142, v44, v45
    v_mfma_f32_16x16x32_bf16 v[48:51], a[176:179], a[88:91], v[48:51]
    s_add_u32 m0, s38, 87040
    v_exp_f32 v46, v46
    v_mfma_f32_16x16x32_bf16 v[48:51], a[200:203], a[92:95], v[48:51]
    buffer_load_dwordx4 v11, s[20:23], s71 offen nt lds
    buffer_load_dwordx4 v0, s[20:23], s71 offen offset:1040 nt lds
    v_mfma_f32_16x16x32_bf16 v[160:163], v[52:55], a[204:207], v[160:163]
    v_exp_f32 v47, v47
    v_mfma_f32_16x16x32_bf16 v[160:163], v[132:135], a[184:187], v[160:163]
    ds_read_b64_tr_b16 a[242:243], v3 offset:4160
    v_cvt_pk_bf16_f32 v143, v46, v47
    v_mfma_f32_16x16x32_bf16 v[228:231], v[60:63], a[188:191], v[228:231]
    v_exp_f32 v48, v48
    v_mfma_f32_16x16x32_bf16 v[228:231], v[116:119], a[192:195], v[228:231]
    ds_read_b128 a[236:239], v1 offset:65280
    ds_read_b128 a[248:251], v1 offset:65344
    v_mfma_f32_16x16x32_bf16 v[32:35], a[168:171], a[96:99], v[28:31]
    v_exp_f32 v49, v49
    v_mfma_f32_16x16x32_bf16 v[32:35], a[172:175], a[100:103], v[32:35]
    ds_read_b128 a[128:131], v1 offset:65408
    v_cvt_pk_bf16_f32 v146, v48, v49
    v_mfma_f32_16x16x32_bf16 v[32:35], a[176:179], a[104:107], v[32:35]
    v_exp_f32 v50, v50
    v_mfma_f32_16x16x32_bf16 v[32:35], a[200:203], a[108:111], v[32:35]
    v_exp_f32 v51, v51
    v_mfma_f32_16x16x32_bf16 v[196:199], v[120:123], a[192:195], v[196:199]
    ds_read_b128 a[252:255], v1 offset:65472
    v_cvt_pk_bf16_f32 v147, v50, v51
    v_mfma_f32_16x16x32_bf16 v[196:199], v[68:71], a[188:191], v[196:199]
    ds_read_b64_tr_b16 a[116:117], v3 offset:16
    ds_read_b64_tr_b16 a[118:119], v3 offset:4176
    v_mfma_f32_16x16x32_bf16 a[20:23], v[128:131], a[188:191], a[20:23]
    v_exp_f32 v32, v32
    v_mfma_f32_16x16x32_bf16 a[20:23], v[124:127], a[192:195], a[20:23]
    v_exp_f32 v33, v33
    v_mfma_f32_16x16x32_bf16 v[164:167], v[52:55], a[192:195], v[164:167]
    ds_read_b64_tr_b16 a[120:121], v5 offset:8720
    v_cvt_pk_bf16_f32 v150, v32, v33
    v_mfma_f32_16x16x32_bf16 v[164:167], v[132:135], a[188:191], v[164:167]
    v_exp_f32 v34, v34
    v_mfma_f32_16x16x32_bf16 v[36:39], a[196:199], a[48:51], v[16:19]
    v_exp_f32 v35, v35
    v_mfma_f32_16x16x32_bf16 v[36:39], a[224:227], a[52:55], v[36:39]
    ds_read_b64_tr_b16 a[122:123], v5 offset:12880
    v_cvt_pk_bf16_f32 v151, v34, v35
    v_mfma_f32_16x16x32_bf16 v[36:39], a[208:211], a[56:59], v[36:39]
    ds_read_b64_tr_b16 a[124:125], v3 offset:32
    ds_read_b64_tr_b16 a[126:127], v3 offset:4192
    v_mfma_f32_16x16x32_bf16 v[36:39], a[232:235], a[60:63], v[36:39]
    s_waitcnt lgkmcnt(4)
    ds_read_b64_tr_b16 a[136:137], v5 offset:8736
    ds_read_b64_tr_b16 a[138:139], v5 offset:12896
    v_mfma_f32_16x16x32_bf16 v[232:235], v[116:119], a[228:231], v[232:235]
    s_nop 1
    v_mfma_f32_16x16x32_bf16 v[232:235], v[60:63], a[220:223], v[232:235]
    s_nop 1
    v_mfma_f32_16x16x32_bf16 v[200:203], v[68:71], a[220:223], v[200:203]
    v_exp_f32 v36, v36
    v_mfma_f32_16x16x32_bf16 v[200:203], v[120:123], a[228:231], v[200:203]
    v_exp_f32 v37, v37
    v_mfma_f32_16x16x32_bf16 v[40:43], a[196:199], a[64:67], v[20:23]
    v_exp_f32 v38, v38
    v_mfma_f32_16x16x32_bf16 v[40:43], a[224:227], a[68:71], v[40:43]
    v_exp_f32 v39, v39
    v_mfma_f32_16x16x32_bf16 v[40:43], a[208:211], a[72:75], v[40:43]
    v_cvt_pk_bf16_f32 v152, v36, v37
    v_cvt_pk_bf16_f32 v153, v38, v39
    v_mfma_f32_16x16x32_bf16 v[40:43], a[232:235], a[76:79], v[40:43]
    s_nop 1
    v_mfma_f32_16x16x32_bf16 a[24:27], v[124:127], a[228:231], a[24:27]
    s_nop 1
    v_mfma_f32_16x16x32_bf16 a[24:27], v[128:131], a[220:223], a[24:27]
    s_add_u32 m0, s28, 8704
    s_nop 1
    v_mfma_f32_16x16x32_bf16 v[168:171], v[132:135], a[220:223], v[168:171]
    buffer_load_dwordx4 v6, s[16:19], s73 offen nt lds
    buffer_load_dwordx4 v7, s[16:19], s73 offen offset:1088 nt lds
    v_mfma_f32_16x16x32_bf16 v[168:171], v[52:55], a[228:231], v[168:171]
    v_exp_f32 v40, v40
    v_mfma_f32_16x16x32_bf16 v[44:47], a[196:199], a[80:83], v[24:27]
    v_exp_f32 v41, v41
    v_mfma_f32_16x16x32_bf16 v[44:47], a[224:227], a[84:87], v[44:47]
    ds_read_b64_tr_b16 a[180:181], v5 offset:8752
    v_cvt_pk_bf16_f32 v156, v40, v41
    v_mfma_f32_16x16x32_bf16 v[44:47], a[208:211], a[88:91], v[44:47]
    v_exp_f32 v42, v42
    v_mfma_f32_16x16x32_bf16 v[44:47], a[232:235], a[92:95], v[44:47]
    v_exp_f32 v43, v43
    v_mfma_f32_16x16x32_bf16 v[236:239], v[116:119], a[216:219], v[236:239]
    ds_read_b64_tr_b16 a[182:183], v5 offset:12912
    v_cvt_pk_bf16_f32 v157, v42, v43
    v_mfma_f32_16x16x32_bf16 v[236:239], v[60:63], a[212:215], v[236:239]
    ds_read_b64_tr_b16 a[148:149], v3 offset:48
    ds_read_b64_tr_b16 a[150:151], v3 offset:4208
    v_mfma_f32_16x16x32_bf16 v[204:207], v[68:71], a[212:215], v[204:207]
    v_exp_f32 v44, v44
    v_mfma_f32_16x16x32_bf16 v[204:207], v[120:123], a[216:219], v[204:207]
    v_exp_f32 v45, v45
    v_mfma_f32_16x16x32_bf16 v[48:51], a[196:199], a[96:99], v[28:31]
    v_exp_f32 v46, v46
    v_mfma_f32_16x16x32_bf16 v[48:51], a[224:227], a[100:103], v[48:51]
    v_exp_f32 v47, v47
    v_mfma_f32_16x16x32_bf16 v[48:51], a[208:211], a[104:107], v[48:51]
    v_cvt_pk_bf16_f32 v76, v44, v45
    v_cvt_pk_bf16_f32 v77, v46, v47
    v_mfma_f32_16x16x32_bf16 v[48:51], a[232:235], a[108:111], v[48:51]
    s_nop 1
    v_mfma_f32_16x16x32_bf16 a[28:31], v[124:127], a[216:219], a[28:31]
    s_nop 1
    v_mfma_f32_16x16x32_bf16 a[28:31], v[128:131], a[212:215], a[28:31]
    s_nop 1
    v_mfma_f32_16x16x32_bf16 v[172:175], v[132:135], a[212:215], v[172:175]
    v_exp_f32 v48, v48
    v_mfma_f32_16x16x32_bf16 v[172:175], v[52:55], a[216:219], v[172:175]
    v_exp_f32 v49, v49
    v_mfma_f32_16x16x32_bf16 v[240:243], v[116:119], a[244:247], v[240:243]
    v_exp_f32 v50, v50
    v_mfma_f32_16x16x32_bf16 v[240:243], v[60:63], a[240:243], v[240:243]
    v_exp_f32 v51, v51
    v_mfma_f32_16x16x32_bf16 v[32:35], a[236:239], a[48:51], v[16:19]
    v_cvt_pk_bf16_f32 v56, v48, v49
    v_cvt_pk_bf16_f32 v57, v50, v51
    v_mfma_f32_16x16x32_bf16 v[32:35], a[248:251], a[52:55], v[32:35]
    v_mfma_f32_16x16x32_bf16 v[32:35], a[128:131], a[56:59], v[32:35]
    v_mfma_f32_16x16x32_bf16 v[32:35], a[252:255], a[60:63], v[32:35]
    s_nop 1
    v_mfma_f32_16x16x32_bf16 v[208:211], v[120:123], a[244:247], v[208:211]
    s_nop 1
    v_mfma_f32_16x16x32_bf16 v[208:211], v[68:71], a[240:243], v[208:211]
    s_nop 1
    v_mfma_f32_16x16x32_bf16 a[32:35], v[128:131], a[240:243], a[32:35]
    v_exp_f32 v32, v32
    v_mfma_f32_16x16x32_bf16 a[32:35], v[124:127], a[244:247], a[32:35]
    v_exp_f32 v33, v33
    v_mfma_f32_16x16x32_bf16 v[36:39], a[236:239], a[64:67], v[20:23]
    s_add_u32 m0, s28, 17408
    v_exp_f32 v34, v34
    v_mfma_f32_16x16x32_bf16 v[36:39], a[248:251], a[68:71], v[36:39]
    buffer_load_dwordx4 v6, s[16:19], s74 offen nt lds
    buffer_load_dwordx4 v7, s[16:19], s74 offen offset:1088 nt lds
    v_mfma_f32_16x16x32_bf16 v[36:39], a[128:131], a[72:75], v[36:39]
    v_exp_f32 v35, v35
    v_mfma_f32_16x16x32_bf16 v[36:39], a[252:255], a[76:79], v[36:39]
    v_cvt_pk_bf16_f32 v154, v32, v33
    v_cvt_pk_bf16_f32 v155, v34, v35
    v_mfma_f32_16x16x32_bf16 v[176:179], v[52:55], a[244:247], v[176:179]
    s_nop 1
    v_mfma_f32_16x16x32_bf16 v[176:179], v[132:135], a[240:243], v[176:179]
    s_nop 1
    v_mfma_f32_16x16x32_bf16 v[244:247], v[60:63], a[116:119], v[244:247]
    s_waitcnt lgkmcnt(0)
    v_exp_f32 v36, v36
    v_mfma_f32_16x16x32_bf16 v[244:247], v[116:119], a[120:123], v[244:247]
    v_exp_f32 v37, v37
    v_mfma_f32_16x16x32_bf16 v[40:43], a[236:239], a[80:83], v[24:27]
    v_exp_f32 v38, v38
    v_mfma_f32_16x16x32_bf16 v[40:43], a[248:251], a[84:87], v[40:43]
    v_exp_f32 v39, v39
    v_mfma_f32_16x16x32_bf16 v[40:43], a[128:131], a[88:91], v[40:43]
    s_waitcnt vmcnt(8)
    s_barrier
    ds_read_b128 a[132:135], v1 offset:0
    ds_read_b128 a[140:143], v1 offset:64
    v_mfma_f32_16x16x32_bf16 v[40:43], a[252:255], a[92:95], v[40:43]
    ds_read_b128 a[144:147], v1 offset:128
    ds_read_b128 a[164:167], v1 offset:192
    v_mfma_f32_16x16x32_bf16 v[212:215], v[120:123], a[120:123], v[212:215]
    v_cvt_pk_bf16_f32 v158, v36, v37
    v_cvt_pk_bf16_f32 v159, v38, v39
    v_mfma_f32_16x16x32_bf16 v[212:215], v[68:71], a[116:119], v[212:215]
    ds_read_b128 a[152:155], v1 offset:4352
    ds_read_b128 a[156:159], v1 offset:4416
    v_mfma_f32_16x16x32_bf16 a[36:39], v[128:131], a[116:119], a[36:39]
    v_exp_f32 v40, v40
    v_mfma_f32_16x16x32_bf16 a[36:39], v[124:127], a[120:123], a[36:39]
    ds_read_b128 a[160:163], v1 offset:4480
    ds_read_b128 a[204:207], v1 offset:4544
    v_mfma_f32_16x16x32_bf16 v[44:47], a[236:239], a[96:99], v[28:31]
    v_exp_f32 v41, v41
    v_mfma_f32_16x16x32_bf16 v[44:47], a[248:251], a[100:103], v[44:47]
    v_exp_f32 v42, v42
    v_mfma_f32_16x16x32_bf16 v[44:47], a[128:131], a[104:107], v[44:47]
    v_exp_f32 v43, v43
    v_mfma_f32_16x16x32_bf16 v[44:47], a[252:255], a[108:111], v[44:47]
    v_cvt_pk_bf16_f32 v78, v40, v41
    v_cvt_pk_bf16_f32 v79, v42, v43
    v_mfma_f32_16x16x32_bf16 v[180:183], v[52:55], a[120:123], v[180:183]
    s_nop 1
    v_mfma_f32_16x16x32_bf16 v[180:183], v[132:135], a[116:119], v[180:183]
    s_nop 1
    v_mfma_f32_16x16x32_bf16 v[248:251], v[60:63], a[124:127], v[248:251]
    v_exp_f32 v44, v44
    v_mfma_f32_16x16x32_bf16 v[248:251], v[116:119], a[136:139], v[248:251]
    v_exp_f32 v45, v45
    v_mfma_f32_16x16x32_bf16 v[216:219], v[120:123], a[136:139], v[216:219]
    v_exp_f32 v46, v46
    v_mfma_f32_16x16x32_bf16 v[216:219], v[68:71], a[124:127], v[216:219]
    s_waitcnt lgkmcnt(0)
    v_exp_f32 v47, v47
    v_mfma_f32_16x16x32_bf16 v[48:51], a[132:135], a[48:51], v[16:19]
    v_cvt_pk_bf16_f32 v58, v44, v45
    v_cvt_pk_bf16_f32 v59, v46, v47
    v_mfma_f32_16x16x32_bf16 v[48:51], a[140:143], a[52:55], v[48:51]
    v_mfma_f32_16x16x32_bf16 v[48:51], a[144:147], a[56:59], v[48:51]
    v_mfma_f32_16x16x32_bf16 v[48:51], a[164:167], a[60:63], v[48:51]
    s_add_u32 m0, s28, 26112
    s_nop 1
    v_mfma_f32_16x16x32_bf16 a[40:43], v[124:127], a[136:139], a[40:43]
    buffer_load_dwordx4 v6, s[16:19], s75 offen nt lds
    buffer_load_dwordx4 v7, s[16:19], s75 offen offset:1088 nt lds
    v_mfma_f32_16x16x32_bf16 a[40:43], v[128:131], a[124:127], a[40:43]
    s_nop 1
    v_mfma_f32_16x16x32_bf16 v[184:187], v[132:135], a[124:127], v[184:187]
    v_exp_f32 v48, v48
    v_mfma_f32_16x16x32_bf16 v[184:187], v[52:55], a[136:139], v[184:187]
    v_exp_f32 v49, v49
    v_mfma_f32_16x16x32_bf16 v[32:35], a[132:135], a[64:67], v[20:23]
    v_exp_f32 v50, v50
    v_mfma_f32_16x16x32_bf16 v[32:35], a[140:143], a[68:71], v[32:35]
    v_exp_f32 v51, v51
    v_mfma_f32_16x16x32_bf16 v[32:35], a[144:147], a[72:75], v[32:35]
    v_cvt_pk_bf16_f32 v64, v48, v49
    v_cvt_pk_bf16_f32 v65, v50, v51
    v_mfma_f32_16x16x32_bf16 v[32:35], a[164:167], a[76:79], v[32:35]
    s_nop 1
    v_mfma_f32_16x16x32_bf16 v[252:255], v[116:119], a[180:183], v[252:255]
    s_nop 1
    v_mfma_f32_16x16x32_bf16 v[252:255], v[60:63], a[148:151], v[252:255]
    s_nop 1
    v_mfma_f32_16x16x32_bf16 v[220:223], v[68:71], a[148:151], v[220:223]
    v_exp_f32 v32, v32
    v_mfma_f32_16x16x32_bf16 v[220:223], v[120:123], a[180:183], v[220:223]
    v_exp_f32 v33, v33
    v_mfma_f32_16x16x32_bf16 v[36:39], a[132:135], a[80:83], v[24:27]
    v_exp_f32 v34, v34
    v_mfma_f32_16x16x32_bf16 v[36:39], a[140:143], a[84:87], v[36:39]
    v_exp_f32 v35, v35
    v_mfma_f32_16x16x32_bf16 v[36:39], a[144:147], a[88:91], v[36:39]
    v_cvt_pk_bf16_f32 v72, v32, v33
    v_cvt_pk_bf16_f32 v73, v34, v35
    v_mfma_f32_16x16x32_bf16 v[36:39], a[164:167], a[92:95], v[36:39]
    s_nop 1
    v_mfma_f32_16x16x32_bf16 a[44:47], v[124:127], a[180:183], a[44:47]
    s_nop 1
    v_mfma_f32_16x16x32_bf16 a[44:47], v[128:131], a[148:151], a[44:47]
    s_nop 1
    v_mfma_f32_16x16x32_bf16 v[188:191], v[132:135], a[148:151], v[188:191]
    v_exp_f32 v36, v36
    v_mfma_f32_16x16x32_bf16 v[188:191], v[52:55], a[180:183], v[188:191]
    v_exp_f32 v37, v37
    v_mfma_f32_16x16x32_bf16 v[40:43], a[132:135], a[96:99], v[28:31]
    s_add_u32 m0, s38, 95744
    v_exp_f32 v38, v38
    v_mfma_f32_16x16x32_bf16 v[40:43], a[140:143], a[100:103], v[40:43]
    buffer_load_dwordx4 v11, s[20:23], s72 offen nt lds
    buffer_load_dwordx4 v0, s[20:23], s72 offen offset:1040 nt lds
    v_mfma_f32_16x16x32_bf16 v[40:43], a[144:147], a[104:107], v[40:43]
    v_exp_f32 v39, v39
    v_mfma_f32_16x16x32_bf16 v[40:43], a[164:167], a[108:111], v[40:43]
    v_cvt_pk_bf16_f32 v80, v36, v37
    v_cvt_pk_bf16_f32 v81, v38, v39
    v_mfma_f32_16x16x32_bf16 a[0:3], a[112:115], v[136:139], a[0:3]
    s_waitcnt vmcnt(6)
    s_barrier
    ds_read_b64_tr_b16 a[184:185], v2 offset:8704
    ds_read_b64_tr_b16 a[186:187], v2 offset:12864
    v_mfma_f32_16x16x32_bf16 a[0:3], a[112:115], v[152:155], a[0:3]
    ds_read_b64_tr_b16 a[168:169], v2 offset:17408
    ds_read_b64_tr_b16 a[170:171], v2 offset:21568
    v_mfma_f32_16x16x32_bf16 a[4:7], a[112:115], v[156:159], a[4:7]
    ds_read_b128 a[172:175], v1 offset:8704
    ds_read_b128 a[176:179], v1 offset:8768
    v_mfma_f32_16x16x32_bf16 a[4:7], a[112:115], v[140:143], a[4:7]
    ds_read_b128 a[200:203], v1 offset:8832
    ds_read_b128 a[192:195], v1 offset:8896
    v_mfma_f32_16x16x32_bf16 v[44:47], a[152:155], a[48:51], v[16:19]
    ds_read_b64_tr_b16 a[188:189], v2 offset:8720
    ds_read_b64_tr_b16 a[190:191], v2 offset:12880
    v_mfma_f32_16x16x32_bf16 v[44:47], a[156:159], a[52:55], v[44:47]
    ds_read_b64_tr_b16 a[220:221], v2 offset:17424
    ds_read_b64_tr_b16 a[222:223], v2 offset:21584
    v_mfma_f32_16x16x32_bf16 v[44:47], a[160:163], a[56:59], v[44:47]
    v_exp_f32 v40, v40
    v_mfma_f32_16x16x32_bf16 v[44:47], a[204:207], a[60:63], v[44:47]
    v_exp_f32 v41, v41
    v_mfma_f32_16x16x32_bf16 a[8:11], a[112:115], v[144:147], a[8:11]
    ds_read_b64_tr_b16 a[228:229], v2 offset:8736
    v_cvt_pk_bf16_f32 v84, v40, v41
    v_mfma_f32_16x16x32_bf16 a[8:11], a[112:115], v[76:79], a[8:11]
    v_exp_f32 v42, v42
    v_mfma_f32_16x16x32_bf16 v[48:51], a[152:155], a[64:67], v[20:23]
    v_exp_f32 v43, v43
    v_mfma_f32_16x16x32_bf16 v[48:51], a[156:159], a[68:71], v[48:51]
    ds_read_b64_tr_b16 a[230:231], v2 offset:12896
    v_cvt_pk_bf16_f32 v85, v42, v43
    v_mfma_f32_16x16x32_bf16 v[48:51], a[160:163], a[72:75], v[48:51]
    v_exp_f32 v44, v44
    v_mfma_f32_16x16x32_bf16 v[48:51], a[204:207], a[76:79], v[48:51]
    v_exp_f32 v45, v45
    v_mfma_f32_16x16x32_bf16 a[12:15], a[112:115], v[148:151], a[12:15]
    ds_read_b64_tr_b16 a[196:197], v2 offset:17440
    v_cvt_pk_bf16_f32 v66, v44, v45
    v_mfma_f32_16x16x32_bf16 a[12:15], a[112:115], v[56:59], a[12:15]
    s_waitcnt lgkmcnt(2)
    v_exp_f32 v46, v46
    v_mfma_f32_16x16x32_bf16 v[224:227], v[136:139], a[184:187], v[224:227]
    v_exp_f32 v47, v47
    v_mfma_f32_16x16x32_bf16 v[224:227], v[152:155], a[168:171], v[224:227]
    s_add_u32 m0, s28, 34816
    ds_read_b64_tr_b16 a[198:199], v2 offset:21600
    v_cvt_pk_bf16_f32 v67, v46, v47
    v_mfma_f32_16x16x32_bf16 v[32:35], a[152:155], a[80:83], v[24:27]
    buffer_load_dwordx4 v6, s[16:19], s76 offen nt lds
    buffer_load_dwordx4 v7, s[16:19], s76 offen offset:1088 nt lds
    v_mfma_f32_16x16x32_bf16 v[32:35], a[156:159], a[84:87], v[32:35]
    v_exp_f32 v48, v48
    v_mfma_f32_16x16x32_bf16 v[32:35], a[160:163], a[88:91], v[32:35]
    v_exp_f32 v49, v49
    v_mfma_f32_16x16x32_bf16 v[32:35], a[204:207], a[92:95], v[32:35]
    ds_read_b128 a[224:227], v1 offset:13056
    v_cvt_pk_bf16_f32 v74, v48, v49
    v_mfma_f32_16x16x32_bf16 v[192:195], v[140:143], a[184:187], v[192:195]
    v_exp_f32 v50, v50
    v_mfma_f32_16x16x32_bf16 v[192:195], v[156:159], a[168:171], v[192:195]
    v_exp_f32 v51, v51
    v_mfma_f32_16x16x32_bf16 v[36:39], a[152:155], a[96:99], v[28:31]
    ds_read_b128 a[208:211], v1 offset:13120
    v_cvt_pk_bf16_f32 v75, v50, v51
    v_mfma_f32_16x16x32_bf16 v[36:39], a[156:159], a[100:103], v[36:39]
    v_exp_f32 v32, v32
    v_mfma_f32_16x16x32_bf16 v[36:39], a[160:163], a[104:107], v[36:39]
    ds_read_b128 a[232:235], v1 offset:13184
    ds_read_b128 a[212:215], v1 offset:13248
    v_mfma_f32_16x16x32_bf16 v[36:39], a[204:207], a[108:111], v[36:39]
    v_exp_f32 v33, v33
    v_mfma_f32_16x16x32_bf16 a[16:19], v[144:147], a[184:187], a[16:19]
    ds_read_b64_tr_b16 a[216:217], v2 offset:17456
    v_cvt_pk_bf16_f32 v82, v32, v33
    v_mfma_f32_16x16x32_bf16 a[16:19], v[76:79], a[168:171], a[16:19]
    v_exp_f32 v34, v34
    v_mfma_f32_16x16x32_bf16 v[160:163], v[56:59], a[168:171], v[160:163]
    v_exp_f32 v35, v35
    v_mfma_f32_16x16x32_bf16 v[160:163], v[148:151], a[184:187], v[160:163]
    ds_read_b64_tr_b16 a[218:219], v2 offset:21616
    v_cvt_pk_bf16_f32 v83, v34, v35
    v_mfma_f32_16x16x32_bf16 v[40:43], a[172:175], a[48:51], v[16:19]
    v_exp_f32 v36, v36
    v_mfma_f32_16x16x32_bf16 v[40:43], a[176:179], a[52:55], v[40:43]
    v_exp_f32 v37, v37
    v_mfma_f32_16x16x32_bf16 v[40:43], a[200:203], a[56:59], v[40:43]
    ds_read_b64_tr_b16 a[244:245], v2 offset:8752
    v_cvt_pk_bf16_f32 v86, v36, v37
    v_mfma_f32_16x16x32_bf16 v[40:43], a[192:195], a[60:63], v[40:43]
    v_exp_f32 v38, v38
    v_mfma_f32_16x16x32_bf16 v[228:231], v[136:139], a[188:191], v[228:231]
    v_exp_f32 v39, v39
    v_mfma_f32_16x16x32_bf16 v[228:231], v[152:155], a[220:223], v[228:231]
    ds_read_b64_tr_b16 a[246:247], v2 offset:12912
    v_cvt_pk_bf16_f32 v87, v38, v39
    v_mfma_f32_16x16x32_bf16 v[44:47], a[172:175], a[64:67], v[20:23]
    s_add_u32 m0, s28, 43520
    v_exp_f32 v40, v40
    v_mfma_f32_16x16x32_bf16 v[44:47], a[176:179], a[68:71], v[44:47]
    buffer_load_dwordx4 v6, s[16:19], s77 offen nt lds
    buffer_load_dwordx4 v7, s[16:19], s77 offen offset:1088 nt lds
    v_mfma_f32_16x16x32_bf16 v[44:47], a[200:203], a[72:75], v[44:47]
    v_exp_f32 v41, v41
    v_mfma_f32_16x16x32_bf16 v[44:47], a[192:195], a[76:79], v[44:47]
    ds_read_b64_tr_b16 a[252:253], v3 offset:8704
    v_cvt_pk_bf16_f32 v100, v40, v41
    v_mfma_f32_16x16x32_bf16 v[196:199], v[140:143], a[188:191], v[196:199]
    v_exp_f32 v42, v42
    v_mfma_f32_16x16x32_bf16 v[196:199], v[156:159], a[220:223], v[196:199]
    v_exp_f32 v43, v43
    v_mfma_f32_16x16x32_bf16 a[20:23], v[76:79], a[220:223], a[20:23]
    ds_read_b64_tr_b16 a[254:255], v3 offset:12864
    v_cvt_pk_bf16_f32 v101, v42, v43
    v_mfma_f32_16x16x32_bf16 a[20:23], v[144:147], a[188:191], a[20:23]
    v_exp_f32 v44, v44
    v_mfma_f32_16x16x32_bf16 v[48:51], a[172:175], a[80:83], v[24:27]
    v_exp_f32 v45, v45
    v_mfma_f32_16x16x32_bf16 v[48:51], a[176:179], a[84:87], v[48:51]
L_pad2:
    s_cbranch_execz L_main
    ds_read_b64_tr_b16 a[120:121], v3 offset:17408
    v_cvt_pk_bf16_f32 v104, v44, v45
    v_mfma_f32_16x16x32_bf16 v[48:51], a[200:203], a[88:91], v[48:51]
    v_exp_f32 v46, v46
    v_mfma_f32_16x16x32_bf16 v[48:51], a[192:195], a[92:95], v[48:51]
    v_exp_f32 v47, v47
    v_mfma_f32_16x16x32_bf16 v[164:167], v[148:151], a[188:191], v[164:167]
    ds_read_b64_tr_b16 a[122:123], v3 offset:21568
    v_cvt_pk_bf16_f32 v105, v46, v47
    v_mfma_f32_16x16x32_bf16 v[164:167], v[56:59], a[220:223], v[164:167]
    ds_read_b64_tr_b16 a[116:117], v3 offset:8720
    ds_read_b64_tr_b16 a[118:119], v3 offset:12880
    v_mfma_f32_16x16x32_bf16 v[32:35], a[172:175], a[96:99], v[28:31]
    v_exp_f32 v48, v48
    v_mfma_f32_16x16x32_bf16 v[32:35], a[176:179], a[100:103], v[32:35]
    v_exp_f32 v49, v49
    v_mfma_f32_16x16x32_bf16 v[32:35], a[200:203], a[104:107], v[32:35]
    ds_read_b64_tr_b16 a[124:125], v3 offset:17424
    v_cvt_pk_bf16_f32 v88, v48, v49
    v_mfma_f32_16x16x32_bf16 v[32:35], a[192:195], a[108:111], v[32:35]
    s_waitcnt lgkmcnt(4)
    v_exp_f32 v50, v50
    v_mfma_f32_16x16x32_bf16 v[232:235], v[136:139], a[228:231], v[232:235]
    v_exp_f32 v51, v51
    v_mfma_f32_16x16x32_bf16 v[232:235], v[152:155], a[196:199], v[232:235]
    ds_read_b64_tr_b16 a[126:127], v3 offset:21584
    v_cvt_pk_bf16_f32 v89, v50, v51
    v_mfma_f32_16x16x32_bf16 v[200:203], v[156:159], a[196:199], v[200:203]
    v_exp_f32 v32, v32
    v_mfma_f32_16x16x32_bf16 v[200:203], v[140:143], a[228:231], v[200:203]
    s_add_u32 m0, s38, 104448
    v_exp_f32 v33, v33
    v_mfma_f32_16x16x32_bf16 v[36:39], a[224:227], a[48:51], v[16:19]
    buffer_load_dwordx4 v11, s[20:23], s73 offen nt lds
    buffer_load_dwordx4 v0, s[20:23], s73 offen offset:1040 nt lds
    v_mfma_f32_16x16x32_bf16 v[36:39], a[208:211], a[52:55], v[36:39]
    v_exp_f32 v34, v34
    v_mfma_f32_16x16x32_bf16 v[36:39], a[232:235], a[56:59], v[36:39]
    v_exp_f32 v35, v35
    v_mfma_f32_16x16x32_bf16 v[36:39], a[212:215], a[60:63], v[36:39]
    v_cvt_pk_bf16_f32 v92, v32, v33
    v_cvt_pk_bf16_f32 v93, v34, v35
    v_mfma_f32_16x16x32_bf16 a[24:27], v[144:147], a[228:231], a[24:27]
    s_nop 1
    v_mfma_f32_16x16x32_bf16 a[24:27], v[76:79], a[196:199], a[24:27]
    s_nop 1
    v_mfma_f32_16x16x32_bf16 v[40:43], a[224:227], a[64:67], v[20:23]
    v_exp_f32 v36, v36
    v_mfma_f32_16x16x32_bf16 v[40:43], a[208:211], a[68:71], v[40:43]
    v_exp_f32 v37, v37
    v_mfma_f32_16x16x32_bf16 v[40:43], a[232:235], a[72:75], v[40:43]
    ds_read_b64_tr_b16 a[140:141], v3 offset:8736
    v_cvt_pk_bf16_f32 v102, v36, v37
    v_mfma_f32_16x16x32_bf16 v[40:43], a[212:215], a[76:79], v[40:43]
    v_exp_f32 v38, v38
    v_mfma_f32_16x16x32_bf16 v[168:171], v[148:151], a[228:231], v[168:171]
    v_exp_f32 v39, v39
    v_mfma_f32_16x16x32_bf16 v[168:171], v[56:59], a[196:199], v[168:171]
    ds_read_b64_tr_b16 a[142:143], v3 offset:12896
    v_cvt_pk_bf16_f32 v103, v38, v39
    v_mfma_f32_16x16x32_bf16 v[236:239], v[152:155], a[216:219], v[236:239]
    s_waitcnt vmcnt(10)
    s_barrier
    ds_read_b128 a[240:243], v1 offset:17408
    ds_read_b128 a[236:239], v1 offset:17472
    v_mfma_f32_16x16x32_bf16 v[236:239], v[136:139], a[244:247], v[236:239]
    ds_read_b128 a[248:251], v1 offset:17536
    ds_read_b128 a[128:131], v1 offset:17600
    v_mfma_f32_16x16x32_bf16 v[44:47], a[224:227], a[80:83], v[24:27]
    v_exp_f32 v40, v40
    v_mfma_f32_16x16x32_bf16 v[44:47], a[208:211], a[84:87], v[44:47]
    v_exp_f32 v41, v41
    v_mfma_f32_16x16x32_bf16 v[44:47], a[232:235], a[88:91], v[44:47]
    ds_read_b128 a[136:139], v1 offset:21760
    v_cvt_pk_bf16_f32 v106, v40, v41
    v_mfma_f32_16x16x32_bf16 v[44:47], a[212:215], a[92:95], v[44:47]
    v_exp_f32 v42, v42
    v_mfma_f32_16x16x32_bf16 v[204:207], v[140:143], a[244:247], v[204:207]
    v_exp_f32 v43, v43
    v_mfma_f32_16x16x32_bf16 v[204:207], v[156:159], a[216:219], v[204:207]
    ds_read_b128 a[148:151], v1 offset:21824
    v_cvt_pk_bf16_f32 v107, v42, v43
    v_mfma_f32_16x16x32_bf16 v[48:51], a[224:227], a[96:99], v[28:31]
    s_add_u32 m0, s28, 52224
    v_exp_f32 v44, v44
    v_mfma_f32_16x16x32_bf16 v[48:51], a[208:211], a[100:103], v[48:51]
    buffer_load_dwordx4 v6, s[16:19], s78 offen nt lds
    buffer_load_dwordx4 v7, s[16:19], s78 offen offset:1088 nt lds
    v_mfma_f32_16x16x32_bf16 v[48:51], a[232:235], a[104:107], v[48:51]
    ds_read_b128 a[180:183], v1 offset:21888
    ds_read_b128 a[132:135], v1 offset:21952
    v_mfma_f32_16x16x32_bf16 v[48:51], a[212:215], a[108:111], v[48:51]
    v_exp_f32 v45, v45
    v_mfma_f32_16x16x32_bf16 a[28:31], v[144:147], a[244:247], a[28:31]
    ds_read_b64_tr_b16 a[144:145], v3 offset:17440
    v_cvt_pk_bf16_f32 v90, v44, v45
    v_mfma_f32_16x16x32_bf16 a[28:31], v[76:79], a[216:219], a[28:31]
    v_exp_f32 v46, v46
    v_mfma_f32_16x16x32_bf16 v[172:175], v[56:59], a[216:219], v[172:175]
    v_exp_f32 v47, v47
    v_mfma_f32_16x16x32_bf16 v[172:175], v[148:151], a[244:247], v[172:175]
    s_waitcnt lgkmcnt(3)
    ds_read_b64_tr_b16 a[146:147], v3 offset:21600
    v_cvt_pk_bf16_f32 v91, v46, v47
    v_mfma_f32_16x16x32_bf16 v[32:35], a[240:243], a[48:51], v[16:19]
    v_exp_f32 v48, v48
    v_mfma_f32_16x16x32_bf16 v[32:35], a[236:239], a[52:55], v[32:35]
    v_exp_f32 v49, v49
    v_mfma_f32_16x16x32_bf16 v[32:35], a[248:251], a[56:59], v[32:35]
    ds_read_b64_tr_b16 a[204:205], v3 offset:17456
    v_cvt_pk_bf16_f32 v94, v48, v49
    v_mfma_f32_16x16x32_bf16 v[32:35], a[128:131], a[60:63], v[32:35]
    v_exp_f32 v50, v50
    v_mfma_f32_16x16x32_bf16 v[240:243], v[136:139], a[252:255], v[240:243]
    v_exp_f32 v51, v51
    v_mfma_f32_16x16x32_bf16 v[240:243], v[152:155], a[120:123], v[240:243]
    ds_read_b64_tr_b16 a[206:207], v3 offset:21616
    v_cvt_pk_bf16_f32 v95, v50, v51
    v_mfma_f32_16x16x32_bf16 v[36:39], a[240:243], a[64:67], v[20:23]
    ds_read_b64_tr_b16 a[168:169], v3 offset:8752
    ds_read_b64_tr_b16 a[170:171], v3 offset:12912
    v_mfma_f32_16x16x32_bf16 v[36:39], a[236:239], a[68:71], v[36:39]
    v_exp_f32 v32, v32
    v_mfma_f32_16x16x32_bf16 v[36:39], a[248:251], a[72:75], v[36:39]
    v_exp_f32 v33, v33
    v_mfma_f32_16x16x32_bf16 v[36:39], a[128:131], a[76:79], v[36:39]
    v_exp_f32 v34, v34
    v_mfma_f32_16x16x32_bf16 v[208:211], v[140:143], a[252:255], v[208:211]
    v_exp_f32 v35, v35
    v_mfma_f32_16x16x32_bf16 v[208:211], v[156:159], a[120:123], v[208:211]
    v_cvt_pk_bf16_f32 v108, v32, v33
    v_cvt_pk_bf16_f32 v109, v34, v35
    v_mfma_f32_16x16x32_bf16 a[32:35], v[76:79], a[120:123], a[32:35]
    s_nop 1
    v_mfma_f32_16x16x32_bf16 a[32:35], v[144:147], a[252:255], a[32:35]
    s_add_u32 m0, s28, 60928
    v_exp_f32 v36, v36
    v_mfma_f32_16x16x32_bf16 v[40:43], a[240:243], a[80:83], v[24:27]
    buffer_load_dwordx4 v6, s[16:19], s79 offen nt lds
    buffer_load_dwordx4 v7, s[16:19], s79 offen offset:1088 nt lds
    v_mfma_f32_16x16x32_bf16 v[40:43], a[236:239], a[84:87], v[40:43]
    v_exp_f32 v37, v37
    v_mfma_f32_16x16x32_bf16 v[40:43], a[248:251], a[88:91], v[40:43]
    v_exp_f32 v38, v38
    v_mfma_f32_16x16x32_bf16 v[40:43], a[128:131], a[92:95], v[40:43]
    v_exp_f32 v39, v39
    v_mfma_f32_16x16x32_bf16 v[176:179], v[148:151], a[252:255], v[176:179]
    v_cvt_pk_bf16_f32 v112, v36, v37
    v_cvt_pk_bf16_f32 v113, v38, v39
    v_mfma_f32_16x16x32_bf16 v[176:179], v[56:59], a[120:123], v[176:179]
    s_nop 1
    v_mfma_f32_16x16x32_bf16 v[44:47], a[240:243], a[96:99], v[28:31]
    v_exp_f32 v40, v40
    v_mfma_f32_16x16x32_bf16 v[44:47], a[236:239], a[100:103], v[44:47]
    v_exp_f32 v41, v41
    v_mfma_f32_16x16x32_bf16 v[44:47], a[248:251], a[104:107], v[44:47]
    v_exp_f32 v42, v42
    v_mfma_f32_16x16x32_bf16 v[44:47], a[128:131], a[108:111], v[44:47]
    v_exp_f32 v43, v43
    v_mfma_f32_16x16x32_bf16 v[244:247], v[136:139], a[116:119], v[244:247]
    v_cvt_pk_bf16_f32 v96, v40, v41
    v_cvt_pk_bf16_f32 v97, v42, v43
    v_mfma_f32_16x16x32_bf16 v[244:247], v[152:155], a[124:127], v[244:247]
    s_nop 1
    v_mfma_f32_16x16x32_bf16 v[212:215], v[156:159], a[124:127], v[212:215]
    v_exp_f32 v44, v44
    v_mfma_f32_16x16x32_bf16 v[212:215], v[140:143], a[116:119], v[212:215]
    v_exp_f32 v45, v45
    v_mfma_f32_16x16x32_bf16 v[48:51], a[136:139], a[48:51], v[16:19]
    v_exp_f32 v46, v46
    v_mfma_f32_16x16x32_bf16 v[48:51], a[148:151], a[52:55], v[48:51]
    s_waitcnt lgkmcnt(0)
    v_exp_f32 v47, v47
    v_mfma_f32_16x16x32_bf16 v[48:51], a[180:183], a[56:59], v[48:51]
    v_cvt_pk_bf16_f32 v116, v44, v45
    v_cvt_pk_bf16_f32 v117, v46, v47
    v_mfma_f32_16x16x32_bf16 v[48:51], a[132:135], a[60:63], v[48:51]
    s_nop 1
    v_mfma_f32_16x16x32_bf16 a[36:39], v[144:147], a[116:119], a[36:39]
    s_nop 1
    v_mfma_f32_16x16x32_bf16 a[36:39], v[76:79], a[124:127], a[36:39]
    s_nop 1
    v_mfma_f32_16x16x32_bf16 v[32:35], a[136:139], a[64:67], v[20:23]
    s_add_u32 m0, s38, 113152
    v_exp_f32 v48, v48
    v_mfma_f32_16x16x32_bf16 v[32:35], a[148:151], a[68:71], v[32:35]
    buffer_load_dwordx4 v11, s[20:23], s74 offen nt lds
    buffer_load_dwordx4 v0, s[20:23], s74 offen offset:1040 nt lds
    v_mfma_f32_16x16x32_bf16 v[32:35], a[180:183], a[72:75], v[32:35]
    v_exp_f32 v49, v49
    v_mfma_f32_16x16x32_bf16 v[32:35], a[132:135], a[76:79], v[32:35]
    v_exp_f32 v50, v50
    v_mfma_f32_16x16x32_bf16 v[180:183], v[148:151], a[116:119], v[180:183]
    s_waitcnt vmcnt(12)
    s_barrier
    ds_read_b128 a[164:167], v1 offset:26112
    ds_read_b128 a[152:155], v1 offset:26176
    v_mfma_f32_16x16x32_bf16 v[180:183], v[56:59], a[124:127], v[180:183]
    ds_read_b128 a[156:159], v1 offset:26240
    ds_read_b128 a[160:163], v1 offset:26304
    v_mfma_f32_16x16x32_bf16 v[36:39], a[136:139], a[80:83], v[24:27]
    ds_read_b128 a[184:187], v1 offset:30464
    v_cvt_pk_bf16_f32 v110, v48, v49
    v_mfma_f32_16x16x32_bf16 v[36:39], a[148:151], a[84:87], v[36:39]
    v_exp_f32 v51, v51
    v_mfma_f32_16x16x32_bf16 v[36:39], a[180:183], a[88:91], v[36:39]
    ds_read_b128 a[188:191], v1 offset:30528
    v_cvt_pk_bf16_f32 v111, v50, v51
    v_mfma_f32_16x16x32_bf16 v[36:39], a[132:135], a[92:95], v[36:39]
    v_exp_f32 v32, v32
    v_mfma_f32_16x16x32_bf16 v[248:251], v[136:139], a[140:143], v[248:251]
    v_exp_f32 v33, v33
    v_mfma_f32_16x16x32_bf16 v[248:251], v[152:155], a[144:147], v[248:251]
    ds_read_b128 a[220:223], v1 offset:30592
    v_cvt_pk_bf16_f32 v114, v32, v33
    v_mfma_f32_16x16x32_bf16 v[216:219], v[156:159], a[144:147], v[216:219]
    v_exp_f32 v34, v34
    v_mfma_f32_16x16x32_bf16 v[216:219], v[140:143], a[140:143], v[216:219]
    v_exp_f32 v35, v35
    v_mfma_f32_16x16x32_bf16 v[40:43], a[136:139], a[96:99], v[28:31]
    ds_read_b128 a[172:175], v1 offset:30656
    v_cvt_pk_bf16_f32 v115, v34, v35
    v_mfma_f32_16x16x32_bf16 v[40:43], a[148:151], a[100:103], v[40:43]
    v_exp_f32 v36, v36
    v_mfma_f32_16x16x32_bf16 v[40:43], a[180:183], a[104:107], v[40:43]
    v_exp_f32 v37, v37
    v_mfma_f32_16x16x32_bf16 v[40:43], a[132:135], a[108:111], v[40:43]
    ds_read_b64_tr_b16 a[176:177], v2 offset:26112
    v_cvt_pk_bf16_f32 v98, v36, v37
    v_mfma_f32_16x16x32_bf16 a[40:43], v[144:147], a[140:143], a[40:43]
    v_exp_f32 v38, v38
    v_mfma_f32_16x16x32_bf16 a[40:43], v[76:79], a[144:147], a[40:43]
    s_waitcnt lgkmcnt(2)
    v_exp_f32 v39, v39
    v_mfma_f32_16x16x32_bf16 v[44:47], a[164:167], a[48:51], v[16:19]
    ds_read_b64_tr_b16 a[178:179], v2 offset:30272
    v_cvt_pk_bf16_f32 v99, v38, v39
    v_mfma_f32_16x16x32_bf16 v[44:47], a[152:155], a[52:55], v[44:47]
    s_add_u32 m0, s38, 121856
    v_exp_f32 v40, v40
    v_mfma_f32_16x16x32_bf16 v[44:47], a[156:159], a[56:59], v[44:47]
    buffer_load_dwordx4 v11, s[20:23], s75 offen nt lds
    buffer_load_dwordx4 v0, s[20:23], s75 offen offset:1040 nt lds
    v_mfma_f32_16x16x32_bf16 v[44:47], a[160:163], a[60:63], v[44:47]
    v_exp_f32 v41, v41
    v_mfma_f32_16x16x32_bf16 v[184:187], v[148:151], a[140:143], v[184:187]
    ds_read_b64_tr_b16 a[200:201], v2 offset:26128
    v_cvt_pk_bf16_f32 v118, v40, v41
    v_mfma_f32_16x16x32_bf16 v[184:187], v[56:59], a[144:147], v[184:187]
    v_exp_f32 v42, v42
    v_mfma_f32_16x16x32_bf16 v[252:255], v[152:155], a[204:207], v[252:255]
    v_exp_f32 v43, v43
    v_mfma_f32_16x16x32_bf16 v[252:255], v[136:139], a[168:171], v[252:255]
    ds_read_b64_tr_b16 a[202:203], v2 offset:30288
    v_cvt_pk_bf16_f32 v119, v42, v43
    v_mfma_f32_16x16x32_bf16 v[48:51], a[164:167], a[64:67], v[20:23]
    v_exp_f32 v44, v44
    v_mfma_f32_16x16x32_bf16 v[48:51], a[152:155], a[68:71], v[48:51]
    v_exp_f32 v45, v45
    v_mfma_f32_16x16x32_bf16 v[48:51], a[156:159], a[72:75], v[48:51]
    ds_read_b64_tr_b16 a[208:209], v2 offset:26144
    v_cvt_pk_bf16_f32 v60, v44, v45
    v_mfma_f32_16x16x32_bf16 v[48:51], a[160:163], a[76:79], v[48:51]
    v_exp_f32 v46, v46
    v_mfma_f32_16x16x32_bf16 v[220:223], v[140:143], a[168:171], v[220:223]
    v_exp_f32 v47, v47
    v_mfma_f32_16x16x32_bf16 v[220:223], v[156:159], a[204:207], v[220:223]
    ds_read_b64_tr_b16 a[210:211], v2 offset:30304
    v_cvt_pk_bf16_f32 v61, v46, v47
    v_mfma_f32_16x16x32_bf16 v[32:35], a[164:167], a[80:83], v[24:27]
    ds_read_b64_tr_b16 a[232:233], v2 offset:26160
    ds_read_b64_tr_b16 a[234:235], v2 offset:30320
    v_mfma_f32_16x16x32_bf16 v[32:35], a[152:155], a[84:87], v[32:35]
    v_exp_f32 v48, v48
    v_mfma_f32_16x16x32_bf16 v[32:35], a[156:159], a[88:91], v[32:35]
    v_exp_f32 v49, v49
    v_mfma_f32_16x16x32_bf16 v[32:35], a[160:163], a[92:95], v[32:35]
    ds_read_b64_tr_b16 a[212:213], v3 offset:26112
    v_cvt_pk_bf16_f32 v68, v48, v49
    v_mfma_f32_16x16x32_bf16 a[44:47], v[144:147], a[168:171], a[44:47]
    v_exp_f32 v50, v50
    v_mfma_f32_16x16x32_bf16 a[44:47], v[76:79], a[204:207], a[44:47]
    v_exp_f32 v51, v51
    v_mfma_f32_16x16x32_bf16 v[188:191], v[56:59], a[204:207], v[188:191]
    ds_read_b64_tr_b16 a[214:215], v3 offset:30272
    v_cvt_pk_bf16_f32 v69, v50, v51
    v_mfma_f32_16x16x32_bf16 v[188:191], v[148:151], a[168:171], v[188:191]
    v_exp_f32 v32, v32
    v_mfma_f32_16x16x32_bf16 v[36:39], a[164:167], a[96:99], v[28:31]
    s_add_u32 m0, s38, 130560
    v_exp_f32 v33, v33
    v_mfma_f32_16x16x32_bf16 v[36:39], a[152:155], a[100:103], v[36:39]
    buffer_load_dwordx4 v11, s[20:23], s76 offen nt lds
    buffer_load_dwordx4 v0, s[20:23], s76 offen offset:1040 nt lds
    v_mfma_f32_16x16x32_bf16 v[36:39], a[156:159], a[104:107], v[36:39]
    v_exp_f32 v34, v34
    v_mfma_f32_16x16x32_bf16 v[36:39], a[160:163], a[108:111], v[36:39]
    v_exp_f32 v35, v35
    v_mfma_f32_16x16x32_bf16 a[0:3], a[112:115], v[64:67], a[0:3]
    v_cvt_pk_bf16_f32 v120, v32, v33
    v_cvt_pk_bf16_f32 v121, v34, v35
    v_mfma_f32_16x16x32_bf16 a[4:7], a[112:115], v[72:75], a[4:7]
    ds_read_b64_tr_b16 a[240:241], v3 offset:26128
    ds_read_b64_tr_b16 a[242:243], v3 offset:30288
    v_mfma_f32_16x16x32_bf16 v[40:43], a[184:187], a[48:51], v[16:19]
    v_exp_f32 v36, v36
    v_mfma_f32_16x16x32_bf16 v[40:43], a[188:191], a[52:55], v[40:43]
    v_exp_f32 v37, v37
    v_mfma_f32_16x16x32_bf16 v[40:43], a[220:223], a[56:59], v[40:43]
    s_waitcnt lgkmcnt(2)
    v_exp_f32 v38, v38
    v_mfma_f32_16x16x32_bf16 v[40:43], a[172:175], a[60:63], v[40:43]
    v_exp_f32 v39, v39
    v_mfma_f32_16x16x32_bf16 a[8:11], a[112:115], v[80:83], a[8:11]
    v_cvt_pk_bf16_f32 v124, v36, v37
    v_cvt_pk_bf16_f32 v125, v38, v39
    v_mfma_f32_16x16x32_bf16 a[12:15], a[112:115], v[84:87], a[12:15]
    s_nop 1
    v_mfma_f32_16x16x32_bf16 v[44:47], a[184:187], a[64:67], v[20:23]
    v_exp_f32 v40, v40
    v_mfma_f32_16x16x32_bf16 v[44:47], a[188:191], a[68:71], v[44:47]
    v_exp_f32 v41, v41
    v_mfma_f32_16x16x32_bf16 v[44:47], a[220:223], a[72:75], v[44:47]
    v_exp_f32 v42, v42
    v_mfma_f32_16x16x32_bf16 v[44:47], a[172:175], a[76:79], v[44:47]
    v_exp_f32 v43, v43
    v_mfma_f32_16x16x32_bf16 v[224:227], v[64:67], a[176:179], v[224:227]
    s_waitcnt vmcnt(14)
    s_barrier
    ds_read_b128 a[192:195], v1 offset:34816
    ds_read_b128 a[228:231], v1 offset:34880
    v_mfma_f32_16x16x32_bf16 v[192:195], v[72:75], a[176:179], v[192:195]
    ds_read_b128 a[196:199], v1 offset:34944
    ds_read_b128 a[224:227], v1 offset:35008
    v_mfma_f32_16x16x32_bf16 a[16:19], v[80:83], a[176:179], a[16:19]
    v_cvt_pk_bf16_f32 v62, v40, v41
    v_cvt_pk_bf16_f32 v63, v42, v43
    v_mfma_f32_16x16x32_bf16 v[48:51], a[184:187], a[80:83], v[24:27]
    v_exp_f32 v44, v44
    v_mfma_f32_16x16x32_bf16 v[48:51], a[188:191], a[84:87], v[48:51]
    v_exp_f32 v45, v45
    v_mfma_f32_16x16x32_bf16 v[48:51], a[220:223], a[88:91], v[48:51]
    s_add_u32 m0, s38, 139264
    ds_read_b128 a[216:219], v1 offset:39168
    v_cvt_pk_bf16_f32 v70, v44, v45
    v_mfma_f32_16x16x32_bf16 v[48:51], a[172:175], a[92:95], v[48:51]
    buffer_load_dwordx4 v11, s[20:23], s77 offen nt lds
    buffer_load_dwordx4 v0, s[20:23], s77 offen offset:1040 nt lds
    v_mfma_f32_16x16x32_bf16 v[160:163], v[84:87], a[176:179], v[160:163]
    v_exp_f32 v46, v46
    v_mfma_f32_16x16x32_bf16 v[228:231], v[64:67], a[200:203], v[228:231]
    v_exp_f32 v47, v47
    v_mfma_f32_16x16x32_bf16 v[32:35], a[184:187], a[96:99], v[28:31]
    ds_read_b128 a[244:247], v1 offset:39232
    v_cvt_pk_bf16_f32 v71, v46, v47
    v_mfma_f32_16x16x32_bf16 v[32:35], a[188:191], a[100:103], v[32:35]
    ds_read_b128 a[252:255], v1 offset:39296
    ds_read_b128 a[120:123], v1 offset:39360
    v_mfma_f32_16x16x32_bf16 v[32:35], a[220:223], a[104:107], v[32:35]
    v_exp_f32 v48, v48
    v_mfma_f32_16x16x32_bf16 v[32:35], a[172:175], a[108:111], v[32:35]
    v_exp_f32 v49, v49
    v_mfma_f32_16x16x32_bf16 v[196:199], v[72:75], a[200:203], v[196:199]
    ds_read_b64_tr_b16 a[236:237], v3 offset:26144
    v_cvt_pk_bf16_f32 v122, v48, v49
    v_mfma_f32_16x16x32_bf16 a[20:23], v[80:83], a[200:203], a[20:23]
    v_exp_f32 v50, v50
    v_mfma_f32_16x16x32_bf16 v[164:167], v[84:87], a[200:203], v[164:167]
    s_waitcnt lgkmcnt(3)
    v_exp_f32 v51, v51
    v_mfma_f32_16x16x32_bf16 v[36:39], a[192:195], a[48:51], v[16:19]
    ds_read_b64_tr_b16 a[238:239], v3 offset:30304
    v_cvt_pk_bf16_f32 v123, v50, v51
    v_mfma_f32_16x16x32_bf16 v[36:39], a[228:231], a[52:55], v[36:39]
    v_exp_f32 v32, v32
    v_mfma_f32_16x16x32_bf16 v[36:39], a[196:199], a[56:59], v[36:39]
    v_exp_f32 v33, v33
    v_mfma_f32_16x16x32_bf16 v[36:39], a[224:227], a[60:63], v[36:39]
    ds_read_b64_tr_b16 a[136:137], v3 offset:26160
    v_cvt_pk_bf16_f32 v126, v32, v33
    v_mfma_f32_16x16x32_bf16 v[232:235], v[64:67], a[208:211], v[232:235]
    v_exp_f32 v34, v34
    v_mfma_f32_16x16x32_bf16 v[200:203], v[72:75], a[208:211], v[200:203]
    v_exp_f32 v35, v35
    v_mfma_f32_16x16x32_bf16 v[40:43], a[192:195], a[64:67], v[20:23]
    ds_read_b64_tr_b16 a[138:139], v3 offset:30320
    v_cvt_pk_bf16_f32 v127, v34, v35
    v_mfma_f32_16x16x32_bf16 v[40:43], a[228:231], a[68:71], v[40:43]
    v_exp_f32 v36, v36
    v_mfma_f32_16x16x32_bf16 v[40:43], a[196:199], a[72:75], v[40:43]
    v_exp_f32 v37, v37
    v_mfma_f32_16x16x32_bf16 v[40:43], a[224:227], a[76:79], v[40:43]
    v_exp_f32 v38, v38
    v_mfma_f32_16x16x32_bf16 a[24:27], v[80:83], a[208:211], a[24:27]
    s_add_u32 m0, s38, 147968
    v_exp_f32 v39, v39
    v_mfma_f32_16x16x32_bf16 v[168:171], v[84:87], a[208:211], v[168:171]
    buffer_load_dwordx4 v11, s[20:23], s78 offen nt lds
    buffer_load_dwordx4 v0, s[20:23], s78 offen offset:1040 nt lds
    v_mfma_f32_16x16x32_bf16 v[44:47], a[192:195], a[80:83], v[24:27]
    v_cvt_pk_bf16_f32 v128, v36, v37
    v_cvt_pk_bf16_f32 v129, v38, v39
    v_mfma_f32_16x16x32_bf16 v[44:47], a[228:231], a[84:87], v[44:47]
    v_exp_f32 v40, v40
    v_mfma_f32_16x16x32_bf16 v[44:47], a[196:199], a[88:91], v[44:47]
    v_exp_f32 v41, v41
    v_mfma_f32_16x16x32_bf16 v[44:47], a[224:227], a[92:95], v[44:47]
    v_exp_f32 v42, v42
    v_mfma_f32_16x16x32_bf16 v[236:239], v[64:67], a[232:235], v[236:239]
    v_exp_f32 v43, v43
    v_mfma_f32_16x16x32_bf16 v[204:207], v[72:75], a[232:235], v[204:207]
    v_cvt_pk_bf16_f32 v132, v40, v41
    v_cvt_pk_bf16_f32 v133, v42, v43
    v_mfma_f32_16x16x32_bf16 a[28:31], v[80:83], a[232:235], a[28:31]
    s_nop 1
    v_mfma_f32_16x16x32_bf16 v[48:51], a[192:195], a[96:99], v[28:31]
    v_exp_f32 v44, v44
    v_mfma_f32_16x16x32_bf16 v[48:51], a[228:231], a[100:103], v[48:51]
    v_exp_f32 v45, v45
    v_mfma_f32_16x16x32_bf16 v[48:51], a[196:199], a[104:107], v[48:51]
    v_exp_f32 v46, v46
    v_mfma_f32_16x16x32_bf16 v[48:51], a[224:227], a[108:111], v[48:51]
    v_exp_f32 v47, v47
    v_mfma_f32_16x16x32_bf16 v[172:175], v[84:87], a[232:235], v[172:175]
    v_cvt_pk_bf16_f32 v52, v44, v45
    v_cvt_pk_bf16_f32 v53, v46, v47
    v_mfma_f32_16x16x32_bf16 v[240:243], v[64:67], a[212:215], v[240:243]
    s_nop 1
    v_mfma_f32_16x16x32_bf16 v[32:35], a[216:219], a[48:51], v[16:19]
    v_exp_f32 v48, v48
    v_mfma_f32_16x16x32_bf16 v[32:35], a[244:247], a[52:55], v[32:35]
    s_waitcnt lgkmcnt(0)
    v_exp_f32 v49, v49
    v_mfma_f32_16x16x32_bf16 v[32:35], a[252:255], a[56:59], v[32:35]
    v_exp_f32 v50, v50
    v_mfma_f32_16x16x32_bf16 v[32:35], a[120:123], a[60:63], v[32:35]
    v_exp_f32 v51, v51
    v_mfma_f32_16x16x32_bf16 v[208:211], v[72:75], a[212:215], v[208:211]
    v_cvt_pk_bf16_f32 v152, v48, v49
    v_cvt_pk_bf16_f32 v153, v50, v51
    v_mfma_f32_16x16x32_bf16 a[32:35], v[80:83], a[212:215], a[32:35]
    s_nop 1
    v_mfma_f32_16x16x32_bf16 v[176:179], v[84:87], a[212:215], v[176:179]
    s_add_u32 m0, s38, 69632
    v_exp_f32 v32, v32
    v_mfma_f32_16x16x32_bf16 v[36:39], a[216:219], a[64:67], v[20:23]
    buffer_load_dwordx4 v11, s[20:23], s79 offen nt lds
    buffer_load_dwordx4 v0, s[20:23], s79 offen offset:1040 nt lds
    v_mfma_f32_16x16x32_bf16 v[36:39], a[244:247], a[68:71], v[36:39]
    v_exp_f32 v33, v33
    v_mfma_f32_16x16x32_bf16 v[36:39], a[252:255], a[72:75], v[36:39]
    v_exp_f32 v34, v34
    v_mfma_f32_16x16x32_bf16 v[36:39], a[120:123], a[76:79], v[36:39]
    s_waitcnt vmcnt(16)
    s_barrier
    ds_read_b128 a[248:251], v1 offset:43520
    ds_read_b128 a[128:131], v1 offset:43584
    v_mfma_f32_16x16x32_bf16 v[244:247], v[64:67], a[240:243], v[244:247]
    ds_read_b128 a[116:119], v1 offset:43648
    ds_read_b128 a[124:127], v1 offset:43712
    v_mfma_f32_16x16x32_bf16 v[212:215], v[72:75], a[240:243], v[212:215]
    ds_read_b128 a[148:151], v1 offset:47872
    v_cvt_pk_bf16_f32 v130, v32, v33
    v_mfma_f32_16x16x32_bf16 v[40:43], a[216:219], a[80:83], v[24:27]
    v_exp_f32 v35, v35
    v_mfma_f32_16x16x32_bf16 v[40:43], a[244:247], a[84:87], v[40:43]
    ds_read_b128 a[180:183], v1 offset:47936
    v_cvt_pk_bf16_f32 v131, v34, v35
    v_mfma_f32_16x16x32_bf16 v[40:43], a[252:255], a[88:91], v[40:43]
    v_exp_f32 v36, v36
    v_mfma_f32_16x16x32_bf16 v[40:43], a[120:123], a[92:95], v[40:43]
    v_exp_f32 v37, v37
    v_mfma_f32_16x16x32_bf16 a[36:39], v[80:83], a[240:243], a[36:39]
    ds_read_b128 a[132:135], v1 offset:48000
    v_cvt_pk_bf16_f32 v134, v36, v37
    v_mfma_f32_16x16x32_bf16 v[180:183], v[84:87], a[240:243], v[180:183]
    v_exp_f32 v38, v38
    v_mfma_f32_16x16x32_bf16 v[44:47], a[216:219], a[96:99], v[28:31]
    v_exp_f32 v39, v39
    v_mfma_f32_16x16x32_bf16 v[44:47], a[244:247], a[100:103], v[44:47]
    ds_read_b128 a[140:143], v1 offset:48064
    v_cvt_pk_bf16_f32 v135, v38, v39
    v_mfma_f32_16x16x32_bf16 v[44:47], a[252:255], a[104:107], v[44:47]
    v_exp_f32 v40, v40
    v_mfma_f32_16x16x32_bf16 v[44:47], a[120:123], a[108:111], v[44:47]
    ds_read_b64_tr_b16 a[144:145], v2 offset:34816
    ds_read_b64_tr_b16 a[146:147], v2 offset:38976
    v_mfma_f32_16x16x32_bf16 v[248:251], v[64:67], a[236:239], v[248:251]
    v_exp_f32 v41, v41
    v_mfma_f32_16x16x32_bf16 v[216:219], v[72:75], a[236:239], v[216:219]
    ds_read_b64_tr_b16 a[204:205], v2 offset:34832
    v_cvt_pk_bf16_f32 v54, v40, v41
    v_mfma_f32_16x16x32_bf16 a[40:43], v[80:83], a[236:239], a[40:43]
    s_waitcnt lgkmcnt(4)
    v_exp_f32 v42, v42
    v_mfma_f32_16x16x32_bf16 v[48:51], a[248:251], a[48:51], v[16:19]
    v_exp_f32 v43, v43
    v_mfma_f32_16x16x32_bf16 v[48:51], a[128:131], a[52:55], v[48:51]
    ds_read_b64_tr_b16 a[206:207], v2 offset:38992
    v_cvt_pk_bf16_f32 v55, v42, v43
    v_mfma_f32_16x16x32_bf16 v[48:51], a[116:119], a[56:59], v[48:51]
    v_exp_f32 v44, v44
    v_mfma_f32_16x16x32_bf16 v[48:51], a[124:127], a[60:63], v[48:51]
    v_exp_f32 v45, v45
    v_mfma_f32_16x16x32_bf16 v[184:187], v[84:87], a[236:239], v[184:187]
    ds_read_b64_tr_b16 a[168:169], v2 offset:34848
    v_cvt_pk_bf16_f32 v154, v44, v45
    v_mfma_f32_16x16x32_bf16 v[252:255], v[64:67], a[136:139], v[252:255]
    v_exp_f32 v46, v46
    v_mfma_f32_16x16x32_bf16 v[32:35], a[248:251], a[64:67], v[20:23]
    v_exp_f32 v47, v47
    v_mfma_f32_16x16x32_bf16 v[32:35], a[128:131], a[68:71], v[32:35]
    ds_read_b64_tr_b16 a[170:171], v2 offset:39008
    v_cvt_pk_bf16_f32 v155, v46, v47
    v_mfma_f32_16x16x32_bf16 v[32:35], a[116:119], a[72:75], v[32:35]
    v_exp_f32 v48, v48
    v_mfma_f32_16x16x32_bf16 v[32:35], a[124:127], a[76:79], v[32:35]
    v_exp_f32 v49, v49
    v_mfma_f32_16x16x32_bf16 v[220:223], v[72:75], a[136:139], v[220:223]
    ds_read_b64_tr_b16 a[176:177], v2 offset:34864
    v_cvt_pk_bf16_f32 v136, v48, v49
    v_mfma_f32_16x16x32_bf16 a[44:47], v[80:83], a[136:139], a[44:47]
    v_exp_f32 v50, v50
    v_mfma_f32_16x16x32_bf16 v[188:191], v[84:87], a[136:139], v[188:191]
    v_exp_f32 v51, v51
    v_mfma_f32_16x16x32_bf16 v[36:39], a[248:251], a[80:83], v[24:27]
    ds_read_b64_tr_b16 a[178:179], v2 offset:39024
    v_cvt_pk_bf16_f32 v137, v50, v51
    v_mfma_f32_16x16x32_bf16 v[36:39], a[128:131], a[84:87], v[36:39]
    v_exp_f32 v32, v32
    v_mfma_f32_16x16x32_bf16 v[36:39], a[116:119], a[88:91], v[36:39]
    v_exp_f32 v33, v33
    v_mfma_f32_16x16x32_bf16 v[36:39], a[124:127], a[92:95], v[36:39]
    ds_read_b64_tr_b16 a[184:185], v3 offset:34816
    v_cvt_pk_bf16_f32 v140, v32, v33
    v_mfma_f32_16x16x32_bf16 a[0:3], a[112:115], v[100:103], a[0:3]
    v_exp_f32 v34, v34
    v_mfma_f32_16x16x32_bf16 a[4:7], a[112:115], v[104:107], a[4:7]
    v_exp_f32 v35, v35
    v_mfma_f32_16x16x32_bf16 v[40:43], a[248:251], a[96:99], v[28:31]
    ds_read_b64_tr_b16 a[186:187], v3 offset:38976
    v_cvt_pk_bf16_f32 v141, v34, v35
    v_mfma_f32_16x16x32_bf16 v[40:43], a[128:131], a[100:103], v[40:43]
    v_exp_f32 v36, v36
    v_mfma_f32_16x16x32_bf16 v[40:43], a[116:119], a[104:107], v[40:43]
    v_exp_f32 v37, v37
    v_mfma_f32_16x16x32_bf16 v[40:43], a[124:127], a[108:111], v[40:43]
    ds_read_b64_tr_b16 a[208:209], v3 offset:34832
    v_cvt_pk_bf16_f32 v156, v36, v37
    v_mfma_f32_16x16x32_bf16 a[8:11], a[112:115], v[88:91], a[8:11]
    v_exp_f32 v38, v38
    v_mfma_f32_16x16x32_bf16 a[12:15], a[112:115], v[92:95], a[12:15]
    v_exp_f32 v39, v39
    v_mfma_f32_16x16x32_bf16 v[44:47], a[148:151], a[48:51], v[16:19]
    ds_read_b64_tr_b16 a[210:211], v3 offset:38992
    v_cvt_pk_bf16_f32 v157, v38, v39
    v_mfma_f32_16x16x32_bf16 v[44:47], a[180:183], a[52:55], v[44:47]
    v_exp_f32 v40, v40
    v_mfma_f32_16x16x32_bf16 v[44:47], a[132:135], a[56:59], v[44:47]
    s_waitcnt lgkmcnt(2)
    v_exp_f32 v41, v41
    v_mfma_f32_16x16x32_bf16 v[44:47], a[140:143], a[60:63], v[44:47]
    v_exp_f32 v42, v42
    v_mfma_f32_16x16x32_bf16 v[224:227], v[100:103], a[144:147], v[224:227]
    ds_read_b64_tr_b16 a[192:193], v3 offset:34848
    v_cvt_pk_bf16_f32 v144, v40, v41
    v_mfma_f32_16x16x32_bf16 v[192:195], v[104:107], a[144:147], v[192:195]
    v_exp_f32 v43, v43
    v_mfma_f32_16x16x32_bf16 a[16:19], v[88:91], a[144:147], a[16:19]
    ds_read_b64_tr_b16 a[194:195], v3 offset:39008
    v_cvt_pk_bf16_f32 v145, v42, v43
    v_mfma_f32_16x16x32_bf16 v[48:51], a[148:151], a[64:67], v[20:23]
    v_exp_f32 v44, v44
    v_mfma_f32_16x16x32_bf16 v[48:51], a[180:183], a[68:71], v[48:51]
    v_exp_f32 v45, v45
    v_mfma_f32_16x16x32_bf16 v[48:51], a[132:135], a[72:75], v[48:51]
    v_exp_f32 v46, v46
    v_mfma_f32_16x16x32_bf16 v[48:51], a[140:143], a[76:79], v[48:51]
    s_waitcnt vmcnt(14)
    s_barrier
    ds_read_b128 a[164:167], v1 offset:52224
    ds_read_b128 a[152:155], v1 offset:52288
    v_mfma_f32_16x16x32_bf16 v[160:163], v[92:95], a[144:147], v[160:163]
    ds_read_b128 a[156:159], v1 offset:52352
    ds_read_b128 a[160:163], v1 offset:52416
    v_mfma_f32_16x16x32_bf16 v[228:231], v[100:103], a[204:207], v[228:231]
    ds_read_b128 a[188:191], v1 offset:56576
    v_cvt_pk_bf16_f32 v138, v44, v45
    v_mfma_f32_16x16x32_bf16 v[32:35], a[148:151], a[80:83], v[24:27]
    v_exp_f32 v47, v47
    v_mfma_f32_16x16x32_bf16 v[32:35], a[180:183], a[84:87], v[32:35]
    ds_read_b128 a[220:223], v1 offset:56640
    v_cvt_pk_bf16_f32 v139, v46, v47
    v_mfma_f32_16x16x32_bf16 v[32:35], a[132:135], a[88:91], v[32:35]
    v_exp_f32 v48, v48
    v_mfma_f32_16x16x32_bf16 v[32:35], a[140:143], a[92:95], v[32:35]
    v_exp_f32 v49, v49
    v_mfma_f32_16x16x32_bf16 v[196:199], v[104:107], a[204:207], v[196:199]
    ds_read_b128 a[172:175], v1 offset:56704
    v_cvt_pk_bf16_f32 v142, v48, v49
    v_mfma_f32_16x16x32_bf16 a[20:23], v[88:91], a[204:207], a[20:23]
L_pad3:
    s_cbranch_execz L_main
    v_exp_f32 v50, v50
    v_mfma_f32_16x16x32_bf16 v[36:39], a[148:151], a[96:99], v[28:31]
    v_exp_f32 v51, v51
    v_mfma_f32_16x16x32_bf16 v[36:39], a[180:183], a[100:103], v[36:39]
    ds_read_b128 a[200:203], v1 offset:56768
    v_cvt_pk_bf16_f32 v143, v50, v51
    v_mfma_f32_16x16x32_bf16 v[36:39], a[132:135], a[104:107], v[36:39]
    v_exp_f32 v32, v32
    v_mfma_f32_16x16x32_bf16 v[36:39], a[140:143], a[108:111], v[36:39]
    v_exp_f32 v33, v33
    v_mfma_f32_16x16x32_bf16 v[164:167], v[92:95], a[204:207], v[164:167]
    ds_read_b64_tr_b16 a[212:213], v3 offset:34864
    v_cvt_pk_bf16_f32 v158, v32, v33
    v_mfma_f32_16x16x32_bf16 v[232:235], v[100:103], a[168:171], v[232:235]
    v_exp_f32 v34, v34
    v_mfma_f32_16x16x32_bf16 v[200:203], v[104:107], a[168:171], v[200:203]
    s_waitcnt lgkmcnt(2)
    v_exp_f32 v35, v35
    v_mfma_f32_16x16x32_bf16 v[40:43], a[164:167], a[48:51], v[16:19]
    ds_read_b64_tr_b16 a[214:215], v3 offset:39024
    v_cvt_pk_bf16_f32 v159, v34, v35
    v_mfma_f32_16x16x32_bf16 v[40:43], a[152:155], a[52:55], v[40:43]
    v_exp_f32 v36, v36
    v_mfma_f32_16x16x32_bf16 v[40:43], a[156:159], a[56:59], v[40:43]
    v_exp_f32 v37, v37
    v_mfma_f32_16x16x32_bf16 v[40:43], a[160:163], a[60:63], v[40:43]
    v_exp_f32 v38, v38
    v_mfma_f32_16x16x32_bf16 a[24:27], v[88:91], a[168:171], a[24:27]
    v_exp_f32 v39, v39
    v_mfma_f32_16x16x32_bf16 v[168:171], v[92:95], a[168:171], v[168:171]
    v_cvt_pk_bf16_f32 v146, v36, v37
    v_cvt_pk_bf16_f32 v147, v38, v39
    v_mfma_f32_16x16x32_bf16 v[44:47], a[164:167], a[64:67], v[20:23]
    s_nop 1
    v_mfma_f32_16x16x32_bf16 v[44:47], a[152:155], a[68:71], v[44:47]
    v_exp_f32 v40, v40
    v_mfma_f32_16x16x32_bf16 v[44:47], a[156:159], a[72:75], v[44:47]
    v_exp_f32 v41, v41
    v_mfma_f32_16x16x32_bf16 v[44:47], a[160:163], a[76:79], v[44:47]
    v_exp_f32 v42, v42
    v_mfma_f32_16x16x32_bf16 v[236:239], v[100:103], a[176:179], v[236:239]
    v_exp_f32 v43, v43
    v_mfma_f32_16x16x32_bf16 v[204:207], v[104:107], a[176:179], v[204:207]
    v_cvt_pk_bf16_f32 v76, v40, v41
    v_cvt_pk_bf16_f32 v77, v42, v43
    v_mfma_f32_16x16x32_bf16 v[48:51], a[164:167], a[80:83], v[24:27]
    s_nop 1
    v_mfma_f32_16x16x32_bf16 v[48:51], a[152:155], a[84:87], v[48:51]
    v_exp_f32 v44, v44
    v_mfma_f32_16x16x32_bf16 v[48:51], a[156:159], a[88:91], v[48:51]
    v_exp_f32 v45, v45
    v_mfma_f32_16x16x32_bf16 v[48:51], a[160:163], a[92:95], v[48:51]
    v_exp_f32 v46, v46
    v_mfma_f32_16x16x32_bf16 a[28:31], v[88:91], a[176:179], a[28:31]
    v_exp_f32 v47, v47
    v_mfma_f32_16x16x32_bf16 v[172:175], v[92:95], a[176:179], v[172:175]
    v_cvt_pk_bf16_f32 v56, v44, v45
    v_cvt_pk_bf16_f32 v57, v46, v47
    v_mfma_f32_16x16x32_bf16 v[32:35], a[164:167], a[96:99], v[28:31]
    s_nop 1
    v_mfma_f32_16x16x32_bf16 v[32:35], a[152:155], a[100:103], v[32:35]
    v_exp_f32 v48, v48
    v_mfma_f32_16x16x32_bf16 v[32:35], a[156:159], a[104:107], v[32:35]
    v_exp_f32 v49, v49
    v_mfma_f32_16x16x32_bf16 v[32:35], a[160:163], a[108:111], v[32:35]
    v_exp_f32 v50, v50
    v_mfma_f32_16x16x32_bf16 v[240:243], v[100:103], a[184:187], v[240:243]
    v_exp_f32 v51, v51
    v_mfma_f32_16x16x32_bf16 v[208:211], v[104:107], a[184:187], v[208:211]
    v_cvt_pk_bf16_f32 v148, v48, v49
    v_cvt_pk_bf16_f32 v149, v50, v51
    v_mfma_f32_16x16x32_bf16 a[32:35], v[88:91], a[184:187], a[32:35]
    s_nop 1
    v_mfma_f32_16x16x32_bf16 v[36:39], a[188:191], a[48:51], v[16:19]
    v_exp_f32 v32, v32
    v_mfma_f32_16x16x32_bf16 v[36:39], a[220:223], a[52:55], v[36:39]
    v_exp_f32 v33, v33
    v_mfma_f32_16x16x32_bf16 v[36:39], a[172:175], a[56:59], v[36:39]
    s_waitcnt lgkmcnt(0)
    v_exp_f32 v34, v34
    v_mfma_f32_16x16x32_bf16 v[36:39], a[200:203], a[60:63], v[36:39]
    v_exp_f32 v35, v35
    v_mfma_f32_16x16x32_bf16 v[176:179], v[92:95], a[184:187], v[176:179]
    v_cvt_pk_bf16_f32 v64, v32, v33
    v_cvt_pk_bf16_f32 v65, v34, v35
    v_mfma_f32_16x16x32_bf16 v[244:247], v[100:103], a[208:211], v[244:247]
    s_nop 1
    v_mfma_f32_16x16x32_bf16 v[40:43], a[188:191], a[64:67], v[20:23]
    v_exp_f32 v36, v36
    v_mfma_f32_16x16x32_bf16 v[40:43], a[220:223], a[68:71], v[40:43]
    v_exp_f32 v37, v37
    v_mfma_f32_16x16x32_bf16 v[40:43], a[172:175], a[72:75], v[40:43]
    v_exp_f32 v38, v38
    v_mfma_f32_16x16x32_bf16 v[40:43], a[200:203], a[76:79], v[40:43]
    s_waitcnt vmcnt(12)
    s_barrier
    ds_read_b128 a[228:231], v1 offset:60928
    ds_read_b128 a[196:199], v1 offset:60992
    v_mfma_f32_16x16x32_bf16 v[212:215], v[104:107], a[208:211], v[212:215]
    ds_read_b128 a[224:227], v1 offset:61056
    ds_read_b128 a[232:235], v1 offset:61120
    v_mfma_f32_16x16x32_bf16 a[36:39], v[88:91], a[208:211], a[36:39]
    ds_read_b128 a[240:243], v1 offset:65280
    v_cvt_pk_bf16_f32 v78, v36, v37
    v_mfma_f32_16x16x32_bf16 v[44:47], a[188:191], a[80:83], v[24:27]
    v_exp_f32 v39, v39
    v_mfma_f32_16x16x32_bf16 v[44:47], a[220:223], a[84:87], v[44:47]
    ds_read_b128 a[216:219], v1 offset:65344
    v_cvt_pk_bf16_f32 v79, v38, v39
    v_mfma_f32_16x16x32_bf16 v[44:47], a[172:175], a[88:91], v[44:47]
    v_exp_f32 v40, v40
    v_mfma_f32_16x16x32_bf16 v[44:47], a[200:203], a[92:95], v[44:47]
    ds_read_b128 a[244:247], v1 offset:65408
    ds_read_b128 a[252:255], v1 offset:65472
    v_mfma_f32_16x16x32_bf16 v[180:183], v[92:95], a[208:211], v[180:183]
    v_exp_f32 v41, v41
    v_mfma_f32_16x16x32_bf16 v[248:251], v[100:103], a[192:195], v[248:251]
    v_exp_f32 v42, v42
    v_mfma_f32_16x16x32_bf16 v[216:219], v[104:107], a[192:195], v[216:219]
    v_exp_f32 v43, v43
    v_mfma_f32_16x16x32_bf16 v[48:51], a[188:191], a[96:99], v[28:31]
    v_cvt_pk_bf16_f32 v58, v40, v41
    v_cvt_pk_bf16_f32 v59, v42, v43
    v_mfma_f32_16x16x32_bf16 v[48:51], a[220:223], a[100:103], v[48:51]
    v_exp_f32 v44, v44
    v_mfma_f32_16x16x32_bf16 v[48:51], a[172:175], a[104:107], v[48:51]
    v_exp_f32 v45, v45
    v_mfma_f32_16x16x32_bf16 v[48:51], a[200:203], a[108:111], v[48:51]
    v_exp_f32 v46, v46
    v_mfma_f32_16x16x32_bf16 a[40:43], v[88:91], a[192:195], a[40:43]
    v_exp_f32 v47, v47
    v_mfma_f32_16x16x32_bf16 v[184:187], v[92:95], a[192:195], v[184:187]
    s_waitcnt lgkmcnt(0)
    v_cvt_pk_bf16_f32 v150, v44, v45
    v_cvt_pk_bf16_f32 v151, v46, v47
    v_mfma_f32_16x16x32_bf16 v[32:35], a[228:231], a[48:51], v[16:19]
    v_exp_f32 v48, v48
    v_mfma_f32_16x16x32_bf16 v[32:35], a[196:199], a[52:55], v[32:35]
    v_exp_f32 v49, v49
    v_mfma_f32_16x16x32_bf16 v[32:35], a[224:227], a[56:59], v[32:35]
    v_exp_f32 v50, v50
    v_mfma_f32_16x16x32_bf16 v[32:35], a[232:235], a[60:63], v[32:35]
    v_exp_f32 v51, v51
    v_mfma_f32_16x16x32_bf16 v[252:255], v[100:103], a[212:215], v[252:255]
    v_cvt_pk_bf16_f32 v66, v48, v49
    v_cvt_pk_bf16_f32 v67, v50, v51
    v_mfma_f32_16x16x32_bf16 v[220:223], v[104:107], a[212:215], v[220:223]
    s_nop 1
    v_mfma_f32_16x16x32_bf16 v[36:39], a[228:231], a[64:67], v[20:23]
    v_exp_f32 v32, v32
    v_mfma_f32_16x16x32_bf16 v[36:39], a[196:199], a[68:71], v[36:39]
    v_exp_f32 v33, v33
    v_mfma_f32_16x16x32_bf16 v[36:39], a[224:227], a[72:75], v[36:39]
    v_exp_f32 v34, v34
    v_mfma_f32_16x16x32_bf16 v[36:39], a[232:235], a[76:79], v[36:39]
    v_exp_f32 v35, v35
    v_mfma_f32_16x16x32_bf16 a[44:47], v[88:91], a[212:215], a[44:47]
    v_cvt_pk_bf16_f32 v72, v32, v33
    v_cvt_pk_bf16_f32 v73, v34, v35
    v_mfma_f32_16x16x32_bf16 v[188:191], v[92:95], a[212:215], v[188:191]
    s_nop 1
    v_mfma_f32_16x16x32_bf16 v[40:43], a[228:231], a[80:83], v[24:27]
    v_exp_f32 v36, v36
    v_mfma_f32_16x16x32_bf16 v[40:43], a[196:199], a[84:87], v[40:43]
    v_exp_f32 v37, v37
    v_mfma_f32_16x16x32_bf16 v[40:43], a[224:227], a[88:91], v[40:43]
    v_exp_f32 v38, v38
    v_mfma_f32_16x16x32_bf16 v[40:43], a[232:235], a[92:95], v[40:43]
    v_exp_f32 v39, v39
    v_mfma_f32_16x16x32_bf16 v[44:47], a[232:235], a[108:111], v[28:31]
    v_cvt_pk_bf16_f32 v80, v36, v37
    v_cvt_pk_bf16_f32 v81, v38, v39
    v_mfma_f32_16x16x32_bf16 v[44:47], a[224:227], a[104:107], v[44:47]
    s_nop 1
    v_mfma_f32_16x16x32_bf16 v[44:47], a[196:199], a[100:103], v[44:47]
    v_exp_f32 v40, v40
    v_mfma_f32_16x16x32_bf16 v[44:47], a[228:231], a[96:99], v[44:47]
    v_exp_f32 v41, v41
    v_mfma_f32_16x16x32_bf16 v[48:51], a[240:243], a[48:51], v[16:19]
    v_exp_f32 v42, v42
    v_mfma_f32_16x16x32_bf16 v[48:51], a[216:219], a[52:55], v[48:51]
    v_exp_f32 v43, v43
    v_mfma_f32_16x16x32_bf16 v[48:51], a[244:247], a[56:59], v[48:51]
    v_cvt_pk_bf16_f32 v84, v40, v41
    v_cvt_pk_bf16_f32 v85, v42, v43
    v_mfma_f32_16x16x32_bf16 v[48:51], a[252:255], a[60:63], v[48:51]
    v_exp_f32 v44, v44
    v_mfma_f32_16x16x32_bf16 v[32:35], a[252:255], a[76:79], v[20:23]
    v_exp_f32 v45, v45
    v_mfma_f32_16x16x32_bf16 v[32:35], a[244:247], a[72:75], v[32:35]
    v_exp_f32 v46, v46
    v_mfma_f32_16x16x32_bf16 v[32:35], a[216:219], a[68:71], v[32:35]
    s_waitcnt vmcnt(0)
    s_barrier
    ds_read_b64_tr_b16 a[120:121], v2 offset:43520
    ds_read_b64_tr_b16 a[122:123], v2 offset:47680
    v_mfma_f32_16x16x32_bf16 v[32:35], a[240:243], a[64:67], v[32:35]
    ds_read_b64_tr_b16 a[236:237], v2 offset:52224
    ds_read_b64_tr_b16 a[238:239], v2 offset:56384
    v_mfma_f32_16x16x32_bf16 v[36:39], a[240:243], a[80:83], v[24:27]
    ds_read_b64_tr_b16 a[136:137], v2 offset:60928
    ds_read_b64_tr_b16 a[138:139], v2 offset:65088
    v_mfma_f32_16x16x32_bf16 v[36:39], a[216:219], a[84:87], v[36:39]
    ds_read_b64_tr_b16 a[248:249], v4 offset:0
    ds_read_b64_tr_b16 a[250:251], v4 offset:4160
    v_mfma_f32_16x16x32_bf16 v[36:39], a[244:247], a[88:91], v[36:39]
    ds_read_b64_tr_b16 a[128:129], v4 offset:8704
    ds_read_b64_tr_b16 a[130:131], v4 offset:12864
    v_mfma_f32_16x16x32_bf16 v[36:39], a[252:255], a[92:95], v[36:39]
    ds_read_b64_tr_b16 a[116:117], v2 offset:0
    ds_read_b64_tr_b16 a[118:119], v2 offset:4160
    v_mfma_f32_16x16x32_bf16 v[40:43], a[252:255], a[108:111], v[28:31]
    ds_read_b64_tr_b16 a[124:125], v2 offset:16
    ds_read_b64_tr_b16 a[126:127], v2 offset:4176
    v_mfma_f32_16x16x32_bf16 v[40:43], a[244:247], a[104:107], v[40:43]
    ds_read_b64_tr_b16 a[144:145], v4 offset:8720
    ds_read_b64_tr_b16 a[146:147], v4 offset:12880
    v_mfma_f32_16x16x32_bf16 v[40:43], a[216:219], a[100:103], v[40:43]
    v_exp_f32 v48, v48
    v_mfma_f32_16x16x32_bf16 v[40:43], a[240:243], a[96:99], v[40:43]
    ds_read_b64_tr_b16 a[148:149], v4 offset:16
    ds_read_b64_tr_b16 a[150:151], v4 offset:4176
    v_mfma_f32_16x16x32_bf16 a[0:3], a[112:115], v[108:111], a[0:3]
    v_exp_f32 v49, v49
    v_mfma_f32_16x16x32_bf16 a[0:3], a[112:115], v[60:63], a[0:3]
    ds_read_b64_tr_b16 a[180:181], v2 offset:60944
    v_cvt_pk_bf16_f32 v74, v48, v49
    v_mfma_f32_16x16x32_bf16 a[0:3], a[112:115], v[128:131], a[0:3]
    ds_read_b64_tr_b16 a[182:183], v2 offset:65104
    ds_read_b64_tr_b16 a[132:133], v2 offset:52240
    v_mfma_f32_16x16x32_bf16 a[0:3], a[112:115], v[136:139], a[0:3]
    v_exp_f32 v50, v50
    v_exp_f32 v51, v51
    s_nop 0
    v_cvt_pk_bf16_f32 v75, v50, v51
    v_mfma_f32_16x16x32_bf16 a[0:3], a[112:115], v[76:79], a[0:3]
    ds_read_b64_tr_b16 a[134:135], v2 offset:56400
    ds_read_b64_tr_b16 a[140:141], v2 offset:43536
    v_mfma_f32_16x16x32_bf16 a[0:3], a[112:115], v[72:75], a[0:3]
    s_waitcnt lgkmcnt(5)
    ds_read_b64_tr_b16 a[142:143], v2 offset:47696
    ds_read_b64_tr_b16 a[204:205], v2 offset:43552
    ds_read_b64_tr_b16 a[206:207], v2 offset:47712
    v_mfma_f32_16x16x32_bf16 v[224:227], v[108:111], a[120:123], v[224:227]
    ds_read_b64_tr_b16 a[168:169], v2 offset:52256
    ds_read_b64_tr_b16 a[170:171], v2 offset:56416
    v_mfma_f32_16x16x32_bf16 v[224:227], v[60:63], a[236:239], v[224:227]
    ds_read_b64_tr_b16 a[176:177], v2 offset:60960
    ds_read_b64_tr_b16 a[178:179], v2 offset:65120
    ds_read_b64_tr_b16 a[164:165], v4 offset:32
    v_mfma_f32_16x16x32_bf16 v[224:227], v[128:131], a[136:139], v[224:227]
    ds_read_b64_tr_b16 a[166:167], v4 offset:4192
    ds_read_b64_tr_b16 a[152:153], v4 offset:8736
    v_mfma_f32_16x16x32_bf16 v[224:227], v[136:139], a[248:251], v[224:227]
    ds_read_b64_tr_b16 a[154:155], v4 offset:12896
    ds_read_b64_tr_b16 a[156:157], v2 offset:32
    ds_read_b64_tr_b16 a[158:159], v2 offset:4192
    v_mfma_f32_16x16x32_bf16 v[224:227], v[76:79], a[128:131], v[224:227]
    ds_read_b64_tr_b16 a[160:161], v2 offset:48
    ds_read_b64_tr_b16 a[162:163], v2 offset:4208
    v_mfma_f32_16x16x32_bf16 v[224:227], v[72:75], a[116:119], v[224:227]
    ds_read_b64_tr_b16 a[184:185], v4 offset:8752
    ds_read_b64_tr_b16 a[186:187], v4 offset:12912
    ds_read_b64_tr_b16 a[208:209], v4 offset:48
    v_mfma_f32_16x16x32_bf16 v[228:231], v[72:75], a[124:127], v[228:231]
    ds_read_b64_tr_b16 a[210:211], v4 offset:4208
    ds_read_b64_tr_b16 a[188:189], v2 offset:60976
    v_mfma_f32_16x16x32_bf16 v[228:231], v[76:79], a[144:147], v[228:231]
    ds_read_b64_tr_b16 a[190:191], v2 offset:65136
    ds_read_b64_tr_b16 a[220:221], v2 offset:52272
    v_accvgpr_read_b32 v16, a0
    v_mfma_f32_16x16x32_bf16 v[228:231], v[136:139], a[148:151], v[228:231]
    s_waitcnt lgkmcnt(12)
    ds_read_b64_tr_b16 a[222:223], v2 offset:56432
    v_cmp_nge_f32 s[88:89], s31, v16
    v_mfma_f32_16x16x32_bf16 v[228:231], v[128:131], a[180:183], v[228:231]
    ds_read_b64_tr_b16 a[172:173], v2 offset:43568
    v_rcp_f32 v16, v16
    v_mfma_f32_16x16x32_bf16 v[228:231], v[60:63], a[132:135], v[228:231]
    ds_write_b32 v12, v16
    v_mfma_f32_16x16x32_bf16 v[228:231], v[108:111], a[140:143], v[228:231]
    ds_read_b128 v[16:19], v13
    ds_read_b64_tr_b16 a[174:175], v2 offset:47728
    ds_read_b64_tr_b16 a[200:201], v3 offset:43520
    v_mfma_f32_16x16x32_bf16 v[232:235], v[108:111], a[204:207], v[232:235]
    ds_read_b64_tr_b16 a[202:203], v3 offset:47680
    ds_read_b64_tr_b16 a[192:193], v3 offset:52224
    v_mfma_f32_16x16x32_bf16 v[232:235], v[60:63], a[168:171], v[232:235]
    ds_read_b64_tr_b16 a[194:195], v3 offset:56384
    ds_read_b64_tr_b16 a[212:213], v3 offset:60928
    ds_read_b64_tr_b16 a[214:215], v3 offset:65088
    v_mfma_f32_16x16x32_bf16 v[232:235], v[128:131], a[176:179], v[232:235]
    ds_read_b64_tr_b16 a[232:233], v5 offset:0
    ds_read_b64_tr_b16 a[234:235], v5 offset:4160
    v_mfma_f32_16x16x32_bf16 v[232:235], v[136:139], a[164:167], v[232:235]
    s_waitcnt lgkmcnt(11)
    s_waitcnt lgkmcnt(9)
    v_mul_f32 v224, v16, v224
    v_mul_f32 v225, v17, v225
    v_mul_f32 v226, v18, v226
    v_mfma_f32_16x16x32_bf16 v[232:235], v[76:79], a[152:155], v[232:235]
    ds_read_b64_tr_b16 a[224:225], v5 offset:8704
    v_mul_f32 v227, v19, v227
    v_mfma_f32_16x16x32_bf16 v[232:235], v[72:75], a[156:159], v[232:235]
    ds_read_b64_tr_b16 a[226:227], v5 offset:12864
    ds_read_b64_tr_b16 a[196:197], v3 offset:0
    ds_read_b64_tr_b16 a[198:199], v3 offset:4160
    v_mfma_f32_16x16x32_bf16 v[236:239], v[72:75], a[160:163], v[236:239]
    v_mul_f32 v228, v16, v228
    v_mul_f32 v229, v17, v229
    v_mfma_f32_16x16x32_bf16 v[236:239], v[76:79], a[184:187], v[236:239]
    v_mul_f32 v230, v18, v230
    v_mul_f32 v231, v19, v231
    v_cvt_pk_bf16_f32 v224, v224, v228
    v_mfma_f32_16x16x32_bf16 v[236:239], v[136:139], a[208:211], v[236:239]
    v_cvt_pk_bf16_f32 v228, v225, v229
    v_cvt_pk_bf16_f32 v226, v226, v230
    v_mfma_f32_16x16x32_bf16 v[236:239], v[128:131], a[188:191], v[236:239]
    ds_read_b64_tr_b16 a[228:229], v3 offset:43536
    ds_read_b64_tr_b16 a[230:231], v3 offset:47696
    v_cvt_pk_bf16_f32 v230, v227, v231
    v_mfma_f32_16x16x32_bf16 v[236:239], v[60:63], a[220:223], v[236:239]
    s_waitcnt lgkmcnt(5)
    ds_read_b64_tr_b16 a[48:49], v3 offset:52240
    ds_read_b64_tr_b16 a[50:51], v3 offset:56400
    v_mfma_f32_16x16x32_bf16 v[236:239], v[108:111], a[172:175], v[236:239]
    ds_read_b64_tr_b16 a[52:53], v3 offset:60944
    ds_read_b64_tr_b16 a[54:55], v3 offset:65104
    ds_read_b64_tr_b16 a[56:57], v5 offset:16
    v_mfma_f32_16x16x32_bf16 v[240:243], v[108:111], a[200:203], v[240:243]
    ds_read_b64_tr_b16 a[58:59], v5 offset:4176
    v_mul_f32 v232, v16, v232
    v_mfma_f32_16x16x32_bf16 v[240:243], v[60:63], a[192:195], v[240:243]
    v_mul_f32 v233, v17, v233
    v_mul_f32 v234, v18, v234
    v_mul_f32 v235, v19, v235
    v_mfma_f32_16x16x32_bf16 v[240:243], v[128:131], a[212:215], v[240:243]
    ds_read_b64_tr_b16 a[60:61], v5 offset:8720
    ds_read_b64_tr_b16 a[62:63], v5 offset:12880
    v_mfma_f32_16x16x32_bf16 v[240:243], v[136:139], a[232:235], v[240:243]
    s_waitcnt lgkmcnt(8)
    ds_read_b64_tr_b16 a[76:77], v3 offset:16
    ds_read_b64_tr_b16 a[78:79], v3 offset:4176
    ds_read_b64_tr_b16 a[72:73], v3 offset:32
    v_mfma_f32_16x16x32_bf16 v[240:243], v[76:79], a[224:227], v[240:243]
    ds_read_b64_tr_b16 a[74:75], v3 offset:4192
    ds_read_b64_tr_b16 a[68:69], v5 offset:8736
    v_mfma_f32_16x16x32_bf16 v[240:243], v[72:75], a[196:199], v[240:243]
    ds_read_b64_tr_b16 a[70:71], v5 offset:12896
    v_exp_f32 v32, v32
    v_mfma_f32_16x16x32_bf16 a[4:7], a[112:115], v[112:115], a[4:7]
    ds_read_b64_tr_b16 a[64:65], v5 offset:32
    ds_read_b64_tr_b16 a[66:67], v5 offset:4192
    v_mfma_f32_16x16x32_bf16 a[4:7], a[112:115], v[68:71], a[4:7]
    ds_read_b64_tr_b16 a[80:81], v3 offset:60960
    v_exp_f32 v33, v33
    v_mfma_f32_16x16x32_bf16 a[4:7], a[112:115], v[132:135], a[4:7]
    ds_read_b64_tr_b16 a[82:83], v3 offset:65120
    v_cvt_pk_bf16_f32 v82, v32, v33
    v_mfma_f32_16x16x32_bf16 a[4:7], a[112:115], v[140:143], a[4:7]
    v_exp_f32 v34, v34
    v_exp_f32 v35, v35
    s_nop 0
    v_cvt_pk_bf16_f32 v83, v34, v35
    v_mfma_f32_16x16x32_bf16 a[4:7], a[112:115], v[56:59], a[4:7]
    v_mul_f32 v236, v16, v236
    v_mul_f32 v237, v17, v237
    v_mfma_f32_16x16x32_bf16 a[4:7], a[112:115], v[80:83], a[4:7]
    v_mul_f32 v238, v18, v238
    v_mul_f32 v239, v19, v239
    v_cvt_pk_bf16_f32 v225, v232, v236
    v_mfma_f32_16x16x32_bf16 v[244:247], v[108:111], a[228:231], v[244:247]
    s_waitcnt lgkmcnt(2)
    v_cvt_pk_bf16_f32 v229, v233, v237
    v_cvt_pk_bf16_f32 v227, v234, v238
    v_mfma_f32_16x16x32_bf16 v[244:247], v[60:63], a[48:51], v[244:247]
    ds_read_b64_tr_b16 a[84:85], v3 offset:52256
    ds_read_b64_tr_b16 a[86:87], v3 offset:56416
    v_cvt_pk_bf16_f32 v231, v235, v239
    v_mfma_f32_16x16x32_bf16 v[244:247], v[128:131], a[52:55], v[244:247]
    ds_write_b64 v8, v[224:225] offset:0
    v_mfma_f32_16x16x32_bf16 v[244:247], v[136:139], a[56:59], v[244:247]
    ds_write_b64 v8, v[228:229] offset:512
    v_mfma_f32_16x16x32_bf16 v[244:247], v[76:79], a[60:63], v[244:247]
    ds_write_b64 v8, v[226:227] offset:1024
    v_mfma_f32_16x16x32_bf16 v[244:247], v[72:75], a[76:79], v[244:247]
    ds_read_b64_tr_b16 a[88:89], v3 offset:43552
    ds_read_b64_tr_b16 a[90:91], v3 offset:47712
    ds_read_b64_tr_b16 v[232:233], v9 offset:0
    v_mfma_f32_16x16x32_bf16 v[248:251], v[72:75], a[72:75], v[248:251]
    ds_read_b64_tr_b16 a[92:93], v3 offset:43568
    ds_read_b64_tr_b16 a[94:95], v3 offset:47728
    v_mfma_f32_16x16x32_bf16 v[248:251], v[76:79], a[68:71], v[248:251]
    ds_read_b64_tr_b16 a[108:109], v3 offset:52272
    ds_read_b64_tr_b16 a[110:111], v3 offset:56432
    ds_read_b64_tr_b16 v[234:235], v14 offset:0
    v_mfma_f32_16x16x32_bf16 v[248:251], v[136:139], a[64:67], v[248:251]
    s_waitcnt lgkmcnt(10)
    ds_read_b64_tr_b16 a[252:253], v3 offset:60976
    ds_read_b64_tr_b16 a[254:255], v3 offset:65136
    v_mfma_f32_16x16x32_bf16 v[248:251], v[128:131], a[80:83], v[248:251]
    ds_read_b64_tr_b16 a[104:105], v5 offset:48
    ds_read_b64_tr_b16 a[106:107], v5 offset:4208
    v_mul_f32 v240, v16, v240
    v_mfma_f32_16x16x32_bf16 v[248:251], v[60:63], a[84:87], v[248:251]
    s_waitcnt lgkmcnt(10)
    ds_read_b64_tr_b16 a[244:245], v5 offset:8752
    ds_read_b64_tr_b16 a[246:247], v5 offset:12912
    v_mfma_f32_16x16x32_bf16 v[248:251], v[108:111], a[88:91], v[248:251]
    s_waitcnt lgkmcnt(9)
    ds_read_b64_tr_b16 a[100:101], v3 offset:48
    ds_read_b64_tr_b16 a[102:103], v3 offset:4208
    v_mul_f32 v241, v17, v241
    v_mfma_f32_16x16x32_bf16 v[252:255], v[108:111], a[92:95], v[252:255]
    s_waitcnt lgkmcnt(9)
    ds_write_b64 v8, v[230:231] offset:1536
    v_mfma_f32_16x16x32_bf16 v[252:255], v[60:63], a[108:111], v[252:255]
    s_waitcnt lgkmcnt(7)
    ds_read_b64_tr_b16 v[236:237], v9 offset:1024
    ds_read_b64_tr_b16 v[238:239], v14 offset:1024
    v_mul_f32 v242, v18, v242
    v_mfma_f32_16x16x32_bf16 v[252:255], v[128:131], a[252:255], v[252:255]
    s_waitcnt lgkmcnt(7)
    buffer_store_dwordx4 v[232:235], v10, s[24:27], s40 offen sc1 nt
    v_mfma_f32_16x16x32_bf16 v[252:255], v[136:139], a[104:107], v[252:255]
    s_waitcnt lgkmcnt(5)
    v_mul_f32 v243, v19, v243
    v_accvgpr_read_b32 v20, a4
    v_mul_f32 v244, v16, v244
    v_mfma_f32_16x16x32_bf16 v[252:255], v[76:79], a[244:247], v[252:255]
    s_waitcnt lgkmcnt(3)
    v_cmp_nge_f32 s[90:91], s31, v20
    v_mul_f32 v245, v17, v245
    v_mfma_f32_16x16x32_bf16 v[252:255], v[72:75], a[100:103], v[252:255]
    s_waitcnt lgkmcnt(0)
    buffer_store_dwordx4 v[236:239], v10, s[24:27], s42 offen sc1 nt
    v_mfma_f32_16x16x32_bf16 v[192:195], v[80:83], a[116:119], v[192:195]
    v_rcp_f32 v20, v20
    v_mfma_f32_16x16x32_bf16 v[192:195], v[56:59], a[128:131], v[192:195]
    ds_write_b32 v12, v20
    v_mul_f32 v246, v18, v246
    v_mfma_f32_16x16x32_bf16 v[192:195], v[140:143], a[248:251], v[192:195]
    ds_read_b128 v[20:23], v13
    v_mul_f32 v247, v19, v247
    v_mfma_f32_16x16x32_bf16 v[192:195], v[132:135], a[136:139], v[192:195]
    v_cvt_pk_bf16_f32 v240, v240, v244
    v_cvt_pk_bf16_f32 v242, v242, v246
    v_mul_f32 v248, v16, v248
    v_mfma_f32_16x16x32_bf16 v[192:195], v[68:71], a[236:239], v[192:195]
    v_cvt_pk_bf16_f32 v244, v241, v245
    v_cvt_pk_bf16_f32 v246, v243, v247
    v_mfma_f32_16x16x32_bf16 v[192:195], v[112:115], a[120:123], v[192:195]
    v_mul_f32 v249, v17, v249
    v_mul_f32 v250, v18, v250
    v_mul_f32 v251, v19, v251
    v_mfma_f32_16x16x32_bf16 v[196:199], v[112:115], a[140:143], v[196:199]
    v_mul_f32 v252, v16, v252
    v_mul_f32 v253, v17, v253
    v_mfma_f32_16x16x32_bf16 v[196:199], v[68:71], a[132:135], v[196:199]
    v_mul_f32 v254, v18, v254
    v_mul_f32 v255, v19, v255
    v_cvt_pk_bf16_f32 v241, v248, v252
    v_mfma_f32_16x16x32_bf16 v[196:199], v[132:135], a[180:183], v[196:199]
    v_cvt_pk_bf16_f32 v245, v249, v253
    v_cvt_pk_bf16_f32 v243, v250, v254
    v_mfma_f32_16x16x32_bf16 v[196:199], v[140:143], a[148:151], v[196:199]
    v_cvt_pk_bf16_f32 v247, v251, v255
    s_waitcnt lgkmcnt(0)
    v_mul_f32 v192, v20, v192
    v_mul_f32 v193, v21, v193
    v_mfma_f32_16x16x32_bf16 v[196:199], v[56:59], a[144:147], v[196:199]
    ds_write_b64 v8, v[240:241] offset:2048
    v_mfma_f32_16x16x32_bf16 v[196:199], v[80:83], a[124:127], v[196:199]
    ds_write_b64 v8, v[244:245] offset:2560
    v_mfma_f32_16x16x32_bf16 v[200:203], v[80:83], a[156:159], v[200:203]
    ds_write_b64 v8, v[242:243] offset:3072
    v_mfma_f32_16x16x32_bf16 v[200:203], v[56:59], a[152:155], v[200:203]
    ds_write_b64 v8, v[246:247] offset:3584
    v_mfma_f32_16x16x32_bf16 v[200:203], v[140:143], a[164:167], v[200:203]
    ds_read_b64_tr_b16 v[248:249], v9 offset:2048
    ds_read_b64_tr_b16 v[250:251], v14 offset:2048
    v_mfma_f32_16x16x32_bf16 v[200:203], v[132:135], a[176:179], v[200:203]
    ds_read_b64_tr_b16 v[252:253], v9 offset:3072
    ds_read_b64_tr_b16 v[254:255], v14 offset:3072
    v_mul_f32 v194, v22, v194
    v_mfma_f32_16x16x32_bf16 v[200:203], v[68:71], a[168:171], v[200:203]
    v_mul_f32 v195, v23, v195
    v_mul_f32 v196, v20, v196
    v_mfma_f32_16x16x32_bf16 v[200:203], v[112:115], a[204:207], v[200:203]
    v_mul_f32 v197, v21, v197
    v_mul_f32 v198, v22, v198
    v_mul_f32 v199, v23, v199
    v_mfma_f32_16x16x32_bf16 v[204:207], v[112:115], a[172:175], v[204:207]
    s_waitcnt lgkmcnt(2)
    buffer_store_dwordx4 v[248:251], v10, s[24:27], s40 offen offset:128 sc1 nt
    v_mfma_f32_16x16x32_bf16 v[204:207], v[68:71], a[220:223], v[204:207]
    s_waitcnt lgkmcnt(0)
    buffer_store_dwordx4 v[252:255], v10, s[24:27], s42 offen offset:128 sc1 nt
    v_mfma_f32_16x16x32_bf16 v[204:207], v[132:135], a[188:191], v[204:207]
    v_cvt_pk_bf16_f32 v192, v192, v196
    v_cvt_pk_bf16_f32 v194, v194, v198
    v_mfma_f32_16x16x32_bf16 v[204:207], v[140:143], a[208:211], v[204:207]
    v_cvt_pk_bf16_f32 v196, v193, v197
    v_cvt_pk_bf16_f32 v198, v195, v199
    v_mul_f32 v200, v20, v200
    v_mfma_f32_16x16x32_bf16 v[204:207], v[56:59], a[184:187], v[204:207]
    v_mul_f32 v201, v21, v201
    v_mul_f32 v202, v22, v202
    v_mfma_f32_16x16x32_bf16 v[204:207], v[80:83], a[160:163], v[204:207]
    v_mul_f32 v203, v23, v203
    v_exp_f32 v36, v36
    v_mfma_f32_16x16x32_bf16 v[208:211], v[80:83], a[196:199], v[208:211]
    v_exp_f32 v37, v37
    v_mfma_f32_16x16x32_bf16 v[208:211], v[56:59], a[224:227], v[208:211]
    v_cvt_pk_bf16_f32 v86, v36, v37
    v_exp_f32 v38, v38
    v_mfma_f32_16x16x32_bf16 v[208:211], v[140:143], a[232:235], v[208:211]
    v_mul_f32 v204, v20, v204
    v_mul_f32 v205, v21, v205
    v_mfma_f32_16x16x32_bf16 v[208:211], v[132:135], a[212:215], v[208:211]
    v_mul_f32 v206, v22, v206
    v_mul_f32 v207, v23, v207
    v_cvt_pk_bf16_f32 v193, v200, v204
    v_mfma_f32_16x16x32_bf16 v[208:211], v[68:71], a[192:195], v[208:211]
    v_cvt_pk_bf16_f32 v197, v201, v205
    v_cvt_pk_bf16_f32 v195, v202, v206
    v_mfma_f32_16x16x32_bf16 v[208:211], v[112:115], a[200:203], v[208:211]
    v_cvt_pk_bf16_f32 v199, v203, v207
    v_exp_f32 v39, v39
    v_mfma_f32_16x16x32_bf16 a[8:11], a[112:115], v[96:99], a[8:11]
    ds_write_b64 v8, v[192:193] offset:4352
    v_mfma_f32_16x16x32_bf16 a[8:11], a[112:115], v[120:123], a[8:11]
    ds_write_b64 v8, v[196:197] offset:4864
    v_mfma_f32_16x16x32_bf16 a[8:11], a[112:115], v[52:55], a[8:11]
    ds_write_b64 v8, v[194:195] offset:5376
    v_mfma_f32_16x16x32_bf16 a[8:11], a[112:115], v[156:159], a[8:11]
    ds_read_b64_tr_b16 v[200:201], v9 offset:4352
    ds_read_b64_tr_b16 v[202:203], v14 offset:4352
    v_cvt_pk_bf16_f32 v87, v38, v39
    v_mfma_f32_16x16x32_bf16 a[8:11], a[112:115], v[148:151], a[8:11]
    ds_write_b64 v8, v[198:199] offset:5888
    v_mfma_f32_16x16x32_bf16 a[8:11], a[112:115], v[84:87], a[8:11]
    ds_read_b64_tr_b16 v[204:205], v9 offset:5376
    ds_read_b64_tr_b16 v[206:207], v14 offset:5376
    v_mul_f32 v208, v20, v208
    v_mfma_f32_16x16x32_bf16 v[212:215], v[112:115], a[228:231], v[212:215]
    v_mul_f32 v209, v21, v209
    v_mul_f32 v210, v22, v210
    v_mfma_f32_16x16x32_bf16 v[212:215], v[68:71], a[48:51], v[212:215]
    v_mul_f32 v211, v23, v211
    v_exp_f32 v40, v40
    v_mfma_f32_16x16x32_bf16 v[212:215], v[132:135], a[52:55], v[212:215]
    s_waitcnt lgkmcnt(3)
    buffer_store_dwordx4 v[200:203], v10, s[24:27], s44 offen sc1 nt
    v_mfma_f32_16x16x32_bf16 v[212:215], v[140:143], a[56:59], v[212:215]
    v_accvgpr_read_b32 v24, a8
    v_cvt_pk_bf16_f32 v100, v44, v45
    v_cmp_nge_f32 s[92:93], s31, v24
    v_mfma_f32_16x16x32_bf16 v[212:215], v[56:59], a[60:63], v[212:215]
    s_waitcnt lgkmcnt(0)
    buffer_store_dwordx4 v[204:207], v10, s[24:27], s46 offen sc1 nt
    v_mfma_f32_16x16x32_bf16 v[212:215], v[80:83], a[76:79], v[212:215]
    v_rcp_f32 v24, v24
    v_mfma_f32_16x16x32_bf16 v[216:219], v[80:83], a[72:75], v[216:219]
    ds_write_b32 v12, v24
    v_mfma_f32_16x16x32_bf16 v[216:219], v[56:59], a[68:71], v[216:219]
    ds_read_b128 v[24:27], v13
    v_exp_f32 v41, v41
    v_mfma_f32_16x16x32_bf16 v[216:219], v[140:143], a[64:67], v[216:219]
    v_exp_f32 v42, v42
    v_mfma_f32_16x16x32_bf16 v[216:219], v[132:135], a[80:83], v[216:219]
    v_mul_f32 v212, v20, v212
    v_mul_f32 v213, v21, v213
    v_mul_f32 v214, v22, v214
    v_mfma_f32_16x16x32_bf16 v[216:219], v[68:71], a[84:87], v[216:219]
    v_mul_f32 v215, v23, v215
    v_cvt_pk_bf16_f32 v208, v208, v212
    v_mfma_f32_16x16x32_bf16 v[216:219], v[112:115], a[88:91], v[216:219]
    v_cvt_pk_bf16_f32 v212, v209, v213
    v_cvt_pk_bf16_f32 v210, v210, v214
    v_cvt_pk_bf16_f32 v102, v40, v41
    v_mfma_f32_16x16x32_bf16 v[220:223], v[112:115], a[92:95], v[220:223]
    v_exp_f32 v47, v47
    v_mfma_f32_16x16x32_bf16 v[220:223], v[68:71], a[108:111], v[220:223]
    v_cvt_pk_bf16_f32 v214, v211, v215
    v_cvt_pk_bf16_f32 v101, v46, v47
    v_mul_f32 v216, v20, v216
    v_mfma_f32_16x16x32_bf16 v[220:223], v[132:135], a[252:255], v[220:223]
    v_mul_f32 v217, v21, v217
    v_mul_f32 v218, v22, v218
    v_mfma_f32_16x16x32_bf16 v[220:223], v[140:143], a[104:107], v[220:223]
    v_exp_f32 v43, v43
    v_mul_f32 v219, v23, v219
    v_mfma_f32_16x16x32_bf16 v[220:223], v[56:59], a[244:247], v[220:223]
    v_cvt_pk_bf16_f32 v103, v42, v43
    v_mfma_f32_16x16x32_bf16 v[220:223], v[80:83], a[100:103], v[220:223]
    s_nop 1
    v_mfma_f32_16x16x32_bf16 a[16:19], v[84:87], a[116:119], a[16:19]
    s_nop 1
    v_mfma_f32_16x16x32_bf16 a[16:19], v[148:151], a[128:131], a[16:19]
    s_nop 1
    v_mfma_f32_16x16x32_bf16 a[16:19], v[156:159], a[248:251], a[16:19]
L_pad4:
    s_cbranch_execz L_main
    v_mul_f32 v220, v20, v220
    v_mul_f32 v221, v21, v221
    v_mfma_f32_16x16x32_bf16 a[16:19], v[52:55], a[136:139], a[16:19]
    v_mul_f32 v222, v22, v222
    v_mul_f32 v223, v23, v223
    v_cvt_pk_bf16_f32 v209, v216, v220
    v_mfma_f32_16x16x32_bf16 a[16:19], v[120:123], a[236:239], a[16:19]
    v_cvt_pk_bf16_f32 v213, v217, v221
    v_cvt_pk_bf16_f32 v211, v218, v222
    v_mfma_f32_16x16x32_bf16 a[16:19], v[96:99], a[120:123], a[16:19]
    v_cvt_pk_bf16_f32 v215, v219, v223
    v_mfma_f32_16x16x32_bf16 a[20:23], v[96:99], a[140:143], a[20:23]
    ds_write_b64 v8, v[208:209] offset:6400
    v_mfma_f32_16x16x32_bf16 a[20:23], v[120:123], a[132:135], a[20:23]
    ds_write_b64 v8, v[212:213] offset:6912
    v_mfma_f32_16x16x32_bf16 a[20:23], v[52:55], a[180:183], a[20:23]
    ds_write_b64 v8, v[210:211] offset:7424
    v_mfma_f32_16x16x32_bf16 a[20:23], v[156:159], a[148:151], a[20:23]
    ds_write_b64 v8, v[214:215] offset:7936
    v_mfma_f32_16x16x32_bf16 a[20:23], v[148:151], a[144:147], a[20:23]
    ds_read_b64_tr_b16 v[216:217], v9 offset:6400
    ds_read_b64_tr_b16 v[218:219], v14 offset:6400
    v_mfma_f32_16x16x32_bf16 a[20:23], v[84:87], a[124:127], a[20:23]
    ds_read_b64_tr_b16 v[220:221], v9 offset:7424
    ds_read_b64_tr_b16 v[222:223], v14 offset:7424
    v_accvgpr_read_b32 v104, a16
    v_mfma_f32_16x16x32_bf16 a[24:27], v[84:87], a[156:159], a[24:27]
    v_accvgpr_read_b32 v105, a17
    v_accvgpr_read_b32 v106, a18
    v_mfma_f32_16x16x32_bf16 a[24:27], v[148:151], a[152:155], a[24:27]
    v_accvgpr_read_b32 v107, a19
    s_waitcnt lgkmcnt(8)
    v_mul_f32 v104, v24, v104
    v_mul_f32 v105, v25, v105
    v_mfma_f32_16x16x32_bf16 a[24:27], v[156:159], a[164:167], a[24:27]
    s_waitcnt lgkmcnt(2)
    buffer_store_dwordx4 v[216:219], v10, s[24:27], s44 offen offset:128 sc1 nt
    v_mfma_f32_16x16x32_bf16 a[24:27], v[52:55], a[176:179], a[24:27]
    s_waitcnt lgkmcnt(0)
    buffer_store_dwordx4 v[220:223], v10, s[24:27], s46 offen offset:128 sc1 nt
    v_mfma_f32_16x16x32_bf16 a[24:27], v[120:123], a[168:171], a[24:27]
    v_mul_f32 v106, v26, v106
    v_mul_f32 v107, v27, v107
    v_mfma_f32_16x16x32_bf16 a[24:27], v[96:99], a[204:207], a[24:27]
    v_accvgpr_read_b32 v88, a20
    v_accvgpr_read_b32 v89, a21
    v_accvgpr_read_b32 v90, a22
    v_mfma_f32_16x16x32_bf16 a[28:31], v[96:99], a[172:175], a[28:31]
    v_accvgpr_read_b32 v91, a23
    v_mul_f32 v88, v24, v88
    v_mfma_f32_16x16x32_bf16 a[28:31], v[120:123], a[220:223], a[28:31]
    v_mul_f32 v89, v25, v89
    v_mul_f32 v90, v26, v90
    v_mul_f32 v91, v27, v91
    v_mfma_f32_16x16x32_bf16 a[28:31], v[52:55], a[188:191], a[28:31]
    v_cvt_pk_bf16_f32 v104, v104, v88
    v_cvt_pk_bf16_f32 v106, v106, v90
    v_mfma_f32_16x16x32_bf16 a[28:31], v[156:159], a[208:211], a[28:31]
    v_cvt_pk_bf16_f32 v88, v105, v89
    v_cvt_pk_bf16_f32 v90, v107, v91
    v_accvgpr_read_b32 v92, a24
    v_mfma_f32_16x16x32_bf16 a[28:31], v[148:151], a[184:187], a[28:31]
    v_accvgpr_read_b32 v93, a25
    v_accvgpr_read_b32 v94, a26
    v_mfma_f32_16x16x32_bf16 a[28:31], v[84:87], a[160:163], a[28:31]
    v_accvgpr_read_b32 v95, a27
    v_mul_f32 v92, v24, v92
    v_mul_f32 v93, v25, v93
    v_mfma_f32_16x16x32_bf16 a[32:35], v[84:87], a[196:199], a[32:35]
    v_mul_f32 v94, v26, v94
    v_mul_f32 v95, v27, v95
    v_mfma_f32_16x16x32_bf16 a[32:35], v[148:151], a[224:227], a[32:35]
    s_nop 1
    v_mfma_f32_16x16x32_bf16 a[32:35], v[156:159], a[232:235], a[32:35]
    v_accvgpr_read_b32 v108, a28
    v_accvgpr_read_b32 v109, a29
    v_mfma_f32_16x16x32_bf16 a[32:35], v[52:55], a[212:215], a[32:35]
    v_accvgpr_read_b32 v110, a30
    v_accvgpr_read_b32 v111, a31
    v_mul_f32 v108, v24, v108
    v_mfma_f32_16x16x32_bf16 a[32:35], v[120:123], a[192:195], a[32:35]
    v_mul_f32 v109, v25, v109
    v_mul_f32 v110, v26, v110
    v_mfma_f32_16x16x32_bf16 a[32:35], v[96:99], a[200:203], a[32:35]
    v_mul_f32 v111, v27, v111
    v_cvt_pk_bf16_f32 v105, v92, v108
    v_cvt_pk_bf16_f32 v89, v93, v109
    v_mfma_f32_16x16x32_bf16 a[12:15], a[112:115], v[116:119], a[12:15]
    v_cvt_pk_bf16_f32 v107, v94, v110
    v_cvt_pk_bf16_f32 v91, v95, v111
    v_mfma_f32_16x16x32_bf16 a[12:15], a[112:115], v[124:127], a[12:15]
    ds_write_b64 v8, v[104:105] offset:0
    v_mfma_f32_16x16x32_bf16 a[12:15], a[112:115], v[152:155], a[12:15]
    ds_write_b64 v8, v[88:89] offset:512
    v_mfma_f32_16x16x32_bf16 a[12:15], a[112:115], v[144:147], a[12:15]
    ds_write_b64 v8, v[106:107] offset:1024
    v_mfma_f32_16x16x32_bf16 a[12:15], a[112:115], v[64:67], a[12:15]
    ds_write_b64 v8, v[90:91] offset:1536
    v_mfma_f32_16x16x32_bf16 a[12:15], a[112:115], v[100:103], a[12:15]
    ds_read_b64_tr_b16 v[92:93], v9 offset:0
    ds_read_b64_tr_b16 v[94:95], v14 offset:0
    ds_read_b64_tr_b16 v[108:109], v9 offset:1024
    v_mfma_f32_16x16x32_bf16 a[36:39], v[96:99], a[228:231], a[36:39]
    ds_read_b64_tr_b16 v[110:111], v14 offset:1024
    v_accvgpr_read_b32 v60, a32
    v_mfma_f32_16x16x32_bf16 a[36:39], v[120:123], a[48:51], a[36:39]
    v_accvgpr_read_b32 v61, a33
    v_accvgpr_read_b32 v62, a34
    v_accvgpr_read_b32 v63, a35
    v_mfma_f32_16x16x32_bf16 a[36:39], v[52:55], a[52:55], a[36:39]
    v_mul_f32 v60, v24, v60
    v_mul_f32 v61, v25, v61
    v_mfma_f32_16x16x32_bf16 a[36:39], v[156:159], a[56:59], a[36:39]
    s_waitcnt lgkmcnt(2)
    buffer_store_dwordx4 v[92:95], v10, s[24:27], s48 offen sc1 nt
    v_mfma_f32_16x16x32_bf16 a[36:39], v[148:151], a[60:63], a[36:39]
    s_waitcnt lgkmcnt(0)
    buffer_store_dwordx4 v[108:111], v10, s[24:27], s50 offen sc1 nt
    v_mfma_f32_16x16x32_bf16 a[36:39], v[84:87], a[76:79], a[36:39]
    v_mul_f32 v62, v26, v62
    v_mul_f32 v63, v27, v63
    v_accvgpr_read_b32 v28, a12
    v_mfma_f32_16x16x32_bf16 a[40:43], v[84:87], a[72:75], a[40:43]
    v_cmp_nge_f32 s[94:95], s31, v28
    v_mfma_f32_16x16x32_bf16 a[40:43], v[148:151], a[68:71], a[40:43]
    v_rcp_f32 v28, v28
    v_mfma_f32_16x16x32_bf16 a[40:43], v[156:159], a[64:67], a[40:43]
    ds_write_b32 v12, v28
    v_mfma_f32_16x16x32_bf16 a[40:43], v[52:55], a[80:83], a[40:43]
    ds_read_b128 v[28:31], v13
    v_accvgpr_read_b32 v128, a36
    v_accvgpr_read_b32 v129, a37
    v_mfma_f32_16x16x32_bf16 a[40:43], v[120:123], a[84:87], a[40:43]
    v_accvgpr_read_b32 v130, a38
    v_accvgpr_read_b32 v131, a39
    v_mfma_f32_16x16x32_bf16 a[40:43], v[96:99], a[88:91], a[40:43]
    v_mul_f32 v128, v24, v128
    v_mul_f32 v129, v25, v129
    v_mul_f32 v130, v26, v130
    v_mfma_f32_16x16x32_bf16 a[44:47], v[96:99], a[92:95], a[44:47]
    v_mul_f32 v131, v27, v131
    v_cvt_pk_bf16_f32 v60, v60, v128
    v_mfma_f32_16x16x32_bf16 a[44:47], v[120:123], a[108:111], a[44:47]
    v_cvt_pk_bf16_f32 v128, v61, v129
    v_cvt_pk_bf16_f32 v62, v62, v130
    v_cvt_pk_bf16_f32 v130, v63, v131
    v_mfma_f32_16x16x32_bf16 a[44:47], v[52:55], a[252:255], a[44:47]
    v_accvgpr_read_b32 v136, a40
    v_accvgpr_read_b32 v137, a41
    v_mfma_f32_16x16x32_bf16 a[44:47], v[156:159], a[104:107], a[44:47]
    v_accvgpr_read_b32 v138, a42
    v_accvgpr_read_b32 v139, a43
    v_mul_f32 v136, v24, v136
    v_mfma_f32_16x16x32_bf16 a[44:47], v[148:151], a[244:247], a[44:47]
    v_mul_f32 v137, v25, v137
    v_mul_f32 v138, v26, v138
    v_mfma_f32_16x16x32_bf16 a[44:47], v[84:87], a[100:103], a[44:47]
    v_mul_f32 v139, v27, v139
    v_mfma_f32_16x16x32_bf16 v[160:163], v[100:103], a[116:119], v[160:163]
    s_nop 1
    v_mfma_f32_16x16x32_bf16 v[160:163], v[64:67], a[128:131], v[160:163]
    s_nop 1
    v_mfma_f32_16x16x32_bf16 v[160:163], v[144:147], a[248:251], v[160:163]
    v_accvgpr_read_b32 v76, a44
    v_accvgpr_read_b32 v77, a45
    v_mfma_f32_16x16x32_bf16 v[160:163], v[152:155], a[136:139], v[160:163]
    v_accvgpr_read_b32 v78, a46
    v_accvgpr_read_b32 v79, a47
    v_mul_f32 v76, v24, v76
    v_mfma_f32_16x16x32_bf16 v[160:163], v[124:127], a[236:239], v[160:163]
    v_mul_f32 v77, v25, v77
    v_mul_f32 v78, v26, v78
    v_mfma_f32_16x16x32_bf16 v[160:163], v[116:119], a[120:123], v[160:163]
    v_mul_f32 v79, v27, v79
    v_cvt_pk_bf16_f32 v61, v136, v76
    v_cvt_pk_bf16_f32 v129, v137, v77
    v_mfma_f32_16x16x32_bf16 v[164:167], v[116:119], a[140:143], v[164:167]
    v_cvt_pk_bf16_f32 v63, v138, v78
    v_cvt_pk_bf16_f32 v131, v139, v79
    v_mfma_f32_16x16x32_bf16 v[164:167], v[124:127], a[132:135], v[164:167]
    ds_write_b64 v8, v[60:61] offset:2048
    v_mfma_f32_16x16x32_bf16 v[164:167], v[152:155], a[180:183], v[164:167]
    ds_write_b64 v8, v[128:129] offset:2560
    v_mfma_f32_16x16x32_bf16 v[164:167], v[144:147], a[148:151], v[164:167]
    ds_write_b64 v8, v[62:63] offset:3072
    v_mfma_f32_16x16x32_bf16 v[164:167], v[64:67], a[144:147], v[164:167]
    ds_write_b64 v8, v[130:131] offset:3584
    v_mfma_f32_16x16x32_bf16 v[164:167], v[100:103], a[124:127], v[164:167]
    ds_read_b64_tr_b16 v[136:137], v9 offset:2048
    ds_read_b64_tr_b16 v[138:139], v14 offset:2048
    ds_read_b64_tr_b16 v[76:77], v9 offset:3072
    v_mfma_f32_16x16x32_bf16 v[168:171], v[100:103], a[156:159], v[168:171]
    ds_read_b64_tr_b16 v[78:79], v14 offset:3072
    s_waitcnt lgkmcnt(8)
    v_mul_f32 v160, v28, v160
    v_mfma_f32_16x16x32_bf16 v[168:171], v[64:67], a[152:155], v[168:171]
    v_mul_f32 v161, v29, v161
    v_mul_f32 v162, v30, v162
    v_mul_f32 v163, v31, v163
    v_mfma_f32_16x16x32_bf16 v[168:171], v[144:147], a[164:167], v[168:171]
    v_mul_f32 v164, v28, v164
    v_mul_f32 v165, v29, v165
    v_mfma_f32_16x16x32_bf16 v[168:171], v[152:155], a[176:179], v[168:171]
    s_waitcnt lgkmcnt(2)
    buffer_store_dwordx4 v[136:139], v10, s[24:27], s48 offen offset:128 sc1 nt
    v_mfma_f32_16x16x32_bf16 v[168:171], v[124:127], a[168:171], v[168:171]
    s_waitcnt lgkmcnt(0)
    buffer_store_dwordx4 v[76:79], v10, s[24:27], s50 offen offset:128 sc1 nt
    v_mfma_f32_16x16x32_bf16 v[168:171], v[116:119], a[204:207], v[168:171]
    v_mul_f32 v166, v30, v166
    v_mul_f32 v167, v31, v167
    v_cvt_pk_bf16_f32 v160, v160, v164
    v_mfma_f32_16x16x32_bf16 v[172:175], v[116:119], a[172:175], v[172:175]
    v_cvt_pk_bf16_f32 v164, v161, v165
    v_cvt_pk_bf16_f32 v162, v162, v166
    v_mfma_f32_16x16x32_bf16 v[172:175], v[124:127], a[220:223], v[172:175]
    v_cvt_pk_bf16_f32 v166, v163, v167
    v_mul_f32 v168, v28, v168
    v_mul_f32 v169, v29, v169
    v_mfma_f32_16x16x32_bf16 v[172:175], v[152:155], a[188:191], v[172:175]
    v_mul_f32 v170, v30, v170
    v_mul_f32 v171, v31, v171
    v_mfma_f32_16x16x32_bf16 v[172:175], v[144:147], a[208:211], v[172:175]
    v_mfma_f32_16x16x32_bf16 v[172:175], v[64:67], a[184:187], v[172:175]
    v_mfma_f32_16x16x32_bf16 v[172:175], v[100:103], a[160:163], v[172:175]
    s_nop 1
    v_mfma_f32_16x16x32_bf16 v[176:179], v[100:103], a[196:199], v[176:179]
    s_nop 1
    v_mfma_f32_16x16x32_bf16 v[176:179], v[64:67], a[224:227], v[176:179]
    s_nop 1
    v_mfma_f32_16x16x32_bf16 v[176:179], v[144:147], a[232:235], v[176:179]
    v_mul_f32 v172, v28, v172
    v_mul_f32 v173, v29, v173
    v_mfma_f32_16x16x32_bf16 v[176:179], v[152:155], a[212:215], v[176:179]
    v_mul_f32 v174, v30, v174
    v_mul_f32 v175, v31, v175
    v_cvt_pk_bf16_f32 v161, v168, v172
    v_mfma_f32_16x16x32_bf16 v[176:179], v[124:127], a[192:195], v[176:179]
    v_cvt_pk_bf16_f32 v165, v169, v173
    v_cvt_pk_bf16_f32 v163, v170, v174
    v_mfma_f32_16x16x32_bf16 v[176:179], v[116:119], a[200:203], v[176:179]
    v_cvt_pk_bf16_f32 v167, v171, v175
    v_mfma_f32_16x16x32_bf16 v[180:183], v[116:119], a[228:231], v[180:183]
    ds_write_b64 v8, v[160:161] offset:4352
    v_mfma_f32_16x16x32_bf16 v[180:183], v[124:127], a[48:51], v[180:183]
    ds_write_b64 v8, v[164:165] offset:4864
    v_mfma_f32_16x16x32_bf16 v[180:183], v[152:155], a[52:55], v[180:183]
    ds_write_b64 v8, v[162:163] offset:5376
    v_mfma_f32_16x16x32_bf16 v[180:183], v[144:147], a[56:59], v[180:183]
    ds_write_b64 v8, v[166:167] offset:5888
    v_mfma_f32_16x16x32_bf16 v[180:183], v[64:67], a[60:63], v[180:183]
    ds_read_b64_tr_b16 v[168:169], v9 offset:4352
    ds_read_b64_tr_b16 v[170:171], v14 offset:4352
    v_mfma_f32_16x16x32_bf16 v[180:183], v[100:103], a[76:79], v[180:183]
    ds_read_b64_tr_b16 v[172:173], v9 offset:5376
    ds_read_b64_tr_b16 v[174:175], v14 offset:5376
    v_mul_f32 v176, v28, v176
    v_mfma_f32_16x16x32_bf16 v[184:187], v[100:103], a[72:75], v[184:187]
    v_mul_f32 v177, v29, v177
    v_mul_f32 v178, v30, v178
    v_mfma_f32_16x16x32_bf16 v[184:187], v[64:67], a[68:71], v[184:187]
    v_mul_f32 v179, v31, v179
    v_mul_f32 v180, v28, v180
    v_mul_f32 v181, v29, v181
    v_mfma_f32_16x16x32_bf16 v[184:187], v[144:147], a[64:67], v[184:187]
    s_waitcnt lgkmcnt(2)
    buffer_store_dwordx4 v[168:171], v10, s[24:27], s52 offen sc1 nt
    v_mfma_f32_16x16x32_bf16 v[184:187], v[152:155], a[80:83], v[184:187]
    s_waitcnt lgkmcnt(0)
    buffer_store_dwordx4 v[172:175], v10, s[24:27], s54 offen sc1 nt
    v_mfma_f32_16x16x32_bf16 v[184:187], v[124:127], a[84:87], v[184:187]
    v_mul_f32 v182, v30, v182
    v_mul_f32 v183, v31, v183
    v_mfma_f32_16x16x32_bf16 v[184:187], v[116:119], a[88:91], v[184:187]
    v_cvt_pk_bf16_f32 v176, v176, v180
    v_cvt_pk_bf16_f32 v178, v178, v182
    v_cvt_pk_bf16_f32 v180, v177, v181
    v_mfma_f32_16x16x32_bf16 v[188:191], v[116:119], a[92:95], v[188:191]
    v_cvt_pk_bf16_f32 v182, v179, v183
    v_mfma_f32_16x16x32_bf16 v[188:191], v[124:127], a[108:111], v[188:191]
    s_nop 1
    v_mfma_f32_16x16x32_bf16 v[188:191], v[152:155], a[252:255], v[188:191]
    v_mul_f32 v184, v28, v184
    v_mul_f32 v185, v29, v185
    v_mfma_f32_16x16x32_bf16 v[188:191], v[144:147], a[104:107], v[188:191]
    v_mul_f32 v186, v30, v186
    v_mul_f32 v187, v31, v187
    v_mfma_f32_16x16x32_bf16 v[188:191], v[64:67], a[244:247], v[188:191]
    v_mfma_f32_16x16x32_bf16 v[188:191], v[100:103], a[100:103], v[188:191]
    s_nop 1
    s_nop 5
    v_pk_mul_f32 v[188:189], v[188:189], v[28:29]
    v_cvt_pk_bf16_f32 v177, v184, v188
    v_cvt_pk_bf16_f32 v181, v185, v189
    ds_write_b64 v8, v[176:177] offset:6400
    ds_write_b64 v8, v[180:181] offset:6912
    v_pk_mul_f32 v[190:191], v[190:191], v[30:31]
    v_cvt_pk_bf16_f32 v179, v186, v190
    v_cvt_pk_bf16_f32 v183, v187, v191
    ds_write_b64 v8, v[178:179] offset:7424
    ds_write_b64 v8, v[182:183] offset:7936
    ds_read_b64_tr_b16 v[184:185], v9 offset:6400
    ds_read_b64_tr_b16 v[186:187], v14 offset:6400
    ds_read_b64_tr_b16 v[188:189], v9 offset:7424
    ds_read_b64_tr_b16 v[190:191], v14 offset:7424
    s_waitcnt lgkmcnt(2)
    buffer_store_dwordx4 v[184:187], v10, s[24:27], s52 offen offset:128 sc1 nt
    s_waitcnt lgkmcnt(0)
    buffer_store_dwordx4 v[188:191], v10, s[24:27], s54 offen offset:128 sc1 nt
    s_or_b64 s[88:89], s[88:89], s[90:91]
    s_or_b64 s[92:93], s[92:93], s[94:95]
    s_or_b64 s[88:89], s[88:89], s[92:93]
    s_cselect_b32 s35, 1, 0
    s_lshl_b32 s30, s3, 2
    s_add_u32 s30, s30, 156672
    v_mov_b32 v12, s30
    v_mov_b32 v13, s35
    v_mov_b32 v14, 156672
    ds_write_b32 v12, v13
    s_waitcnt lgkmcnt(0)
    s_barrier
    ds_read_b128 v[16:19], v14
    s_waitcnt lgkmcnt(0)
    v_or3_b32 v16, v16, v17, v18
    v_or_b32 v16, v16, v19
    s_nop 0
    v_readfirstlane_b32 s35, v16
    s_nop 1
    s_andn2_b32 s35, s35, s29
    s_cbranch_scc1 L_rerun
L_end:
    s_endpgm
L_codeend:
L_rerun:
    s_mov_b32 s29, 1
    s_waitcnt vmcnt(0) lgkmcnt(0)
    s_barrier
    v_mbcnt_lo_u32_b32 v0, -1, 0
    v_mbcnt_hi_u32_b32 v0, -1, v0
    s_lshl_b32 s35, s3, 6
    v_add_u32 v0, s35, v0
    s_branch L_start
L_maxpass:
    v_bfe_u32 v154, v152, 2, 2
    v_lshrrev_b32 v155, 4, v152
    v_lshl_add_u32 v155, v155, 4, 64
    v_lshl_add_u32 v154, v154, 8, v155
    v_and_b32 v144, 1, v152
    v_lshl_add_u32 v155, v144, 10, v154
    v_bfe_u32 v144, v152, 1, 1
    v_lshl_add_u32 v155, v144, 11, v155
    v_and_b32 v144, 3, v152
    v_lshl_add_u32 v154, v144, 10, v154
    buffer_load_dwordx4 v[128:131], v155, s[12:15], s40 offen offset:0
    buffer_load_dwordx4 v[132:135], v155, s[12:15], s40 offen offset:64
    buffer_load_dwordx4 v[136:139], v155, s[12:15], s40 offen offset:128
    buffer_load_dwordx4 v[140:143], v155, s[12:15], s40 offen offset:192
    s_waitcnt vmcnt(0)
    v_lshlrev_b32 v144, 16, v128
    v_and_b32 v145, 0xffff0000, v128
    v_lshlrev_b32 v146, 16, v129
    v_and_b32 v147, 0xffff0000, v129
    v_lshlrev_b32 v148, 16, v130
    v_and_b32 v149, 0xffff0000, v130
    v_lshlrev_b32 v150, 16, v131
    v_and_b32 v151, 0xffff0000, v131
    v_pk_mul_f32 v[144:145], v[144:145], s[30:31] op_sel_hi:[1,0]
    v_pk_mul_f32 v[146:147], v[146:147], s[30:31] op_sel_hi:[1,0]
    v_pk_mul_f32 v[148:149], v[148:149], s[30:31] op_sel_hi:[1,0]
    v_pk_mul_f32 v[150:151], v[150:151], s[30:31] op_sel_hi:[1,0]
    v_cvt_pk_bf16_f32 v144, v144, v145
    v_cvt_pk_bf16_f32 v146, v146, v147
    v_cvt_pk_bf16_f32 v148, v148, v149
    v_cvt_pk_bf16_f32 v150, v150, v151
    v_accvgpr_write_b32 a48, v144
    v_accvgpr_write_b32 a49, v146
    v_accvgpr_write_b32 a50, v148
    v_accvgpr_write_b32 a51, v150
    v_lshlrev_b32 v144, 16, v132
    v_and_b32 v145, 0xffff0000, v132
    v_lshlrev_b32 v146, 16, v133
    v_and_b32 v147, 0xffff0000, v133
    v_lshlrev_b32 v148, 16, v134
    v_and_b32 v149, 0xffff0000, v134
    v_lshlrev_b32 v150, 16, v135
    v_and_b32 v151, 0xffff0000, v135
    v_pk_mul_f32 v[144:145], v[144:145], s[30:31] op_sel_hi:[1,0]
    v_pk_mul_f32 v[146:147], v[146:147], s[30:31] op_sel_hi:[1,0]
    v_pk_mul_f32 v[148:149], v[148:149], s[30:31] op_sel_hi:[1,0]
    v_pk_mul_f32 v[150:151], v[150:151], s[30:31] op_sel_hi:[1,0]
    v_cvt_pk_bf16_f32 v144, v144, v145
    v_cvt_pk_bf16_f32 v146, v146, v147
    v_cvt_pk_bf16_f32 v148, v148, v149
    v_cvt_pk_bf16_f32 v150, v150, v151
    v_accvgpr_write_b32 a52, v144
    v_accvgpr_write_b32 a53, v146
    v_accvgpr_write_b32 a54, v148
    v_accvgpr_write_b32 a55, v150
    v_lshlrev_b32 v144, 16, v136
    v_and_b32 v145, 0xffff0000, v136
    v_lshlrev_b32 v146, 16, v137
    v_and_b32 v147, 0xffff0000, v137
    v_lshlrev_b32 v148, 16, v138
    v_and_b32 v149, 0xffff0000, v138
    v_lshlrev_b32 v150, 16, v139
    v_and_b32 v151, 0xffff0000, v139
    v_pk_mul_f32 v[144:145], v[144:145], s[30:31] op_sel_hi:[1,0]
    v_pk_mul_f32 v[146:147], v[146:147], s[30:31] op_sel_hi:[1,0]
    v_pk_mul_f32 v[148:149], v[148:149], s[30:31] op_sel_hi:[1,0]
    v_pk_mul_f32 v[150:151], v[150:151], s[30:31] op_sel_hi:[1,0]
    v_cvt_pk_bf16_f32 v144, v144, v145
    v_cvt_pk_bf16_f32 v146, v146, v147
    v_cvt_pk_bf16_f32 v148, v148, v149
    v_cvt_pk_bf16_f32 v150, v150, v151
    v_accvgpr_write_b32 a56, v144
    v_accvgpr_write_b32 a57, v146
    v_accvgpr_write_b32 a58, v148
    v_accvgpr_write_b32 a59, v150
    v_lshlrev_b32 v144, 16, v140
    v_and_b32 v145, 0xffff0000, v140
    v_lshlrev_b32 v146, 16, v141
    v_and_b32 v147, 0xffff0000, v141
    v_lshlrev_b32 v148, 16, v142
    v_and_b32 v149, 0xffff0000, v142
    v_lshlrev_b32 v150, 16, v143
    v_and_b32 v151, 0xffff0000, v143
    v_pk_mul_f32 v[144:145], v[144:145], s[30:31] op_sel_hi:[1,0]
    v_pk_mul_f32 v[146:147], v[146:147], s[30:31] op_sel_hi:[1,0]
    v_pk_mul_f32 v[148:149], v[148:149], s[30:31] op_sel_hi:[1,0]
    v_pk_mul_f32 v[150:151], v[150:151], s[30:31] op_sel_hi:[1,0]
    v_cvt_pk_bf16_f32 v144, v144, v145
    v_cvt_pk_bf16_f32 v146, v146, v147
    v_cvt_pk_bf16_f32 v148, v148, v149
    v_cvt_pk_bf16_f32 v150, v150, v151
    v_accvgpr_write_b32 a60, v144
    v_accvgpr_write_b32 a61, v146
    v_accvgpr_write_b32 a62, v148
    v_accvgpr_write_b32 a63, v150
    buffer_load_dwordx4 v[128:131], v155, s[12:15], s44 offen offset:0
    buffer_load_dwordx4 v[132:135], v155, s[12:15], s44 offen offset:64
    buffer_load_dwordx4 v[136:139], v155, s[12:15], s44 offen offset:128
    buffer_load_dwordx4 v[140:143], v155, s[12:15], s44 offen offset:192
    s_waitcnt vmcnt(0)
    v_lshlrev_b32 v144, 16, v128
    v_and_b32 v145, 0xffff0000, v128
    v_lshlrev_b32 v146, 16, v129
    v_and_b32 v147, 0xffff0000, v129
    v_lshlrev_b32 v148, 16, v130
    v_and_b32 v149, 0xffff0000, v130
    v_lshlrev_b32 v150, 16, v131
    v_and_b32 v151, 0xffff0000, v131
    v_pk_mul_f32 v[144:145], v[144:145], s[30:31] op_sel_hi:[1,0]
    v_pk_mul_f32 v[146:147], v[146:147], s[30:31] op_sel_hi:[1,0]
    v_pk_mul_f32 v[148:149], v[148:149], s[30:31] op_sel_hi:[1,0]
    v_pk_mul_f32 v[150:151], v[150:151], s[30:31] op_sel_hi:[1,0]
    v_cvt_pk_bf16_f32 v144, v144, v145
    v_cvt_pk_bf16_f32 v146, v146, v147
    v_cvt_pk_bf16_f32 v148, v148, v149
    v_cvt_pk_bf16_f32 v150, v150, v151
    v_accvgpr_write_b32 a64, v144
    v_accvgpr_write_b32 a65, v146
    v_accvgpr_write_b32 a66, v148
    v_accvgpr_write_b32 a67, v150
    v_lshlrev_b32 v144, 16, v132
    v_and_b32 v145, 0xffff0000, v132
    v_lshlrev_b32 v146, 16, v133
    v_and_b32 v147, 0xffff0000, v133
    v_lshlrev_b32 v148, 16, v134
    v_and_b32 v149, 0xffff0000, v134
    v_lshlrev_b32 v150, 16, v135
    v_and_b32 v151, 0xffff0000, v135
    v_pk_mul_f32 v[144:145], v[144:145], s[30:31] op_sel_hi:[1,0]
    v_pk_mul_f32 v[146:147], v[146:147], s[30:31] op_sel_hi:[1,0]
    v_pk_mul_f32 v[148:149], v[148:149], s[30:31] op_sel_hi:[1,0]
    v_pk_mul_f32 v[150:151], v[150:151], s[30:31] op_sel_hi:[1,0]
    v_cvt_pk_bf16_f32 v144, v144, v145
    v_cvt_pk_bf16_f32 v146, v146, v147
    v_cvt_pk_bf16_f32 v148, v148, v149
    v_cvt_pk_bf16_f32 v150, v150, v151
    v_accvgpr_write_b32 a68, v144
    v_accvgpr_write_b32 a69, v146
    v_accvgpr_write_b32 a70, v148
    v_accvgpr_write_b32 a71, v150
    v_lshlrev_b32 v144, 16, v136
    v_and_b32 v145, 0xffff0000, v136
    v_lshlrev_b32 v146, 16, v137
    v_and_b32 v147, 0xffff0000, v137
    v_lshlrev_b32 v148, 16, v138
    v_and_b32 v149, 0xffff0000, v138
    v_lshlrev_b32 v150, 16, v139
    v_and_b32 v151, 0xffff0000, v139
    v_pk_mul_f32 v[144:145], v[144:145], s[30:31] op_sel_hi:[1,0]
    v_pk_mul_f32 v[146:147], v[146:147], s[30:31] op_sel_hi:[1,0]
    v_pk_mul_f32 v[148:149], v[148:149], s[30:31] op_sel_hi:[1,0]
    v_pk_mul_f32 v[150:151], v[150:151], s[30:31] op_sel_hi:[1,0]
    v_cvt_pk_bf16_f32 v144, v144, v145
    v_cvt_pk_bf16_f32 v146, v146, v147
    v_cvt_pk_bf16_f32 v148, v148, v149
    v_cvt_pk_bf16_f32 v150, v150, v151
    v_accvgpr_write_b32 a72, v144
    v_accvgpr_write_b32 a73, v146
    v_accvgpr_write_b32 a74, v148
    v_accvgpr_write_b32 a75, v150
    v_lshlrev_b32 v144, 16, v140
    v_and_b32 v145, 0xffff0000, v140
    v_lshlrev_b32 v146, 16, v141
    v_and_b32 v147, 0xffff0000, v141
    v_lshlrev_b32 v148, 16, v142
    v_and_b32 v149, 0xffff0000, v142
    v_lshlrev_b32 v150, 16, v143
    v_and_b32 v151, 0xffff0000, v143
    v_pk_mul_f32 v[144:145], v[144:145], s[30:31] op_sel_hi:[1,0]
    v_pk_mul_f32 v[146:147], v[146:147], s[30:31] op_sel_hi:[1,0]
    v_pk_mul_f32 v[148:149], v[148:149], s[30:31] op_sel_hi:[1,0]
    v_pk_mul_f32 v[150:151], v[150:151], s[30:31] op_sel_hi:[1,0]
    v_cvt_pk_bf16_f32 v144, v144, v145
    v_cvt_pk_bf16_f32 v146, v146, v147
    v_cvt_pk_bf16_f32 v148, v148, v149
    v_cvt_pk_bf16_f32 v150, v150, v151
    v_accvgpr_write_b32 a76, v144
    v_accvgpr_write_b32 a77, v146
    v_accvgpr_write_b32 a78, v148
    v_accvgpr_write_b32 a79, v150
    buffer_load_dwordx4 v[128:131], v155, s[12:15], s48 offen offset:0
    buffer_load_dwordx4 v[132:135], v155, s[12:15], s48 offen offset:64
    buffer_load_dwordx4 v[136:139], v155, s[12:15], s48 offen offset:128
    buffer_load_dwordx4 v[140:143], v155, s[12:15], s48 offen offset:192
    s_waitcnt vmcnt(0)
    v_lshlrev_b32 v144, 16, v128
    v_and_b32 v145, 0xffff0000, v128
    v_lshlrev_b32 v146, 16, v129
    v_and_b32 v147, 0xffff0000, v129
    v_lshlrev_b32 v148, 16, v130
    v_and_b32 v149, 0xffff0000, v130
    v_lshlrev_b32 v150, 16, v131
    v_and_b32 v151, 0xffff0000, v131
    v_pk_mul_f32 v[144:145], v[144:145], s[30:31] op_sel_hi:[1,0]
    v_pk_mul_f32 v[146:147], v[146:147], s[30:31] op_sel_hi:[1,0]
    v_pk_mul_f32 v[148:149], v[148:149], s[30:31] op_sel_hi:[1,0]
    v_pk_mul_f32 v[150:151], v[150:151], s[30:31] op_sel_hi:[1,0]
    v_cvt_pk_bf16_f32 v144, v144, v145
    v_cvt_pk_bf16_f32 v146, v146, v147
    v_cvt_pk_bf16_f32 v148, v148, v149
    v_cvt_pk_bf16_f32 v150, v150, v151
    v_accvgpr_write_b32 a80, v144
    v_accvgpr_write_b32 a81, v146
    v_accvgpr_write_b32 a82, v148
    v_accvgpr_write_b32 a83, v150
    v_lshlrev_b32 v144, 16, v132
    v_and_b32 v145, 0xffff0000, v132
    v_lshlrev_b32 v146, 16, v133
    v_and_b32 v147, 0xffff0000, v133
    v_lshlrev_b32 v148, 16, v134
    v_and_b32 v149, 0xffff0000, v134
    v_lshlrev_b32 v150, 16, v135
    v_and_b32 v151, 0xffff0000, v135
    v_pk_mul_f32 v[144:145], v[144:145], s[30:31] op_sel_hi:[1,0]
    v_pk_mul_f32 v[146:147], v[146:147], s[30:31] op_sel_hi:[1,0]
    v_pk_mul_f32 v[148:149], v[148:149], s[30:31] op_sel_hi:[1,0]
    v_pk_mul_f32 v[150:151], v[150:151], s[30:31] op_sel_hi:[1,0]
    v_cvt_pk_bf16_f32 v144, v144, v145
    v_cvt_pk_bf16_f32 v146, v146, v147
    v_cvt_pk_bf16_f32 v148, v148, v149
    v_cvt_pk_bf16_f32 v150, v150, v151
    v_accvgpr_write_b32 a84, v144
    v_accvgpr_write_b32 a85, v146
    v_accvgpr_write_b32 a86, v148
    v_accvgpr_write_b32 a87, v150
    v_lshlrev_b32 v144, 16, v136
    v_and_b32 v145, 0xffff0000, v136
    v_lshlrev_b32 v146, 16, v137
    v_and_b32 v147, 0xffff0000, v137
    v_lshlrev_b32 v148, 16, v138
    v_and_b32 v149, 0xffff0000, v138
    v_lshlrev_b32 v150, 16, v139
    v_and_b32 v151, 0xffff0000, v139
    v_pk_mul_f32 v[144:145], v[144:145], s[30:31] op_sel_hi:[1,0]
    v_pk_mul_f32 v[146:147], v[146:147], s[30:31] op_sel_hi:[1,0]
    v_pk_mul_f32 v[148:149], v[148:149], s[30:31] op_sel_hi:[1,0]
    v_pk_mul_f32 v[150:151], v[150:151], s[30:31] op_sel_hi:[1,0]
    v_cvt_pk_bf16_f32 v144, v144, v145
    v_cvt_pk_bf16_f32 v146, v146, v147
    v_cvt_pk_bf16_f32 v148, v148, v149
    v_cvt_pk_bf16_f32 v150, v150, v151
    v_accvgpr_write_b32 a88, v144
    v_accvgpr_write_b32 a89, v146
    v_accvgpr_write_b32 a90, v148
    v_accvgpr_write_b32 a91, v150
    v_lshlrev_b32 v144, 16, v140
    v_and_b32 v145, 0xffff0000, v140
    v_lshlrev_b32 v146, 16, v141
    v_and_b32 v147, 0xffff0000, v141
    v_lshlrev_b32 v148, 16, v142
    v_and_b32 v149, 0xffff0000, v142
    v_lshlrev_b32 v150, 16, v143
    v_and_b32 v151, 0xffff0000, v143
    v_pk_mul_f32 v[144:145], v[144:145], s[30:31] op_sel_hi:[1,0]
    v_pk_mul_f32 v[146:147], v[146:147], s[30:31] op_sel_hi:[1,0]
    v_pk_mul_f32 v[148:149], v[148:149], s[30:31] op_sel_hi:[1,0]
    v_pk_mul_f32 v[150:151], v[150:151], s[30:31] op_sel_hi:[1,0]
    v_cvt_pk_bf16_f32 v144, v144, v145
    v_cvt_pk_bf16_f32 v146, v146, v147
    v_cvt_pk_bf16_f32 v148, v148, v149
    v_cvt_pk_bf16_f32 v150, v150, v151
    v_accvgpr_write_b32 a92, v144
    v_accvgpr_write_b32 a93, v146
    v_accvgpr_write_b32 a94, v148
    v_accvgpr_write_b32 a95, v150
    buffer_load_dwordx4 v[128:131], v155, s[12:15], s52 offen offset:0
    buffer_load_dwordx4 v[132:135], v155, s[12:15], s52 offen offset:64
    buffer_load_dwordx4 v[136:139], v155, s[12:15], s52 offen offset:128
    buffer_load_dwordx4 v[140:143], v155, s[12:15], s52 offen offset:192
    s_waitcnt vmcnt(0)
    v_lshlrev_b32 v144, 16, v128
    v_and_b32 v145, 0xffff0000, v128
    v_lshlrev_b32 v146, 16, v129
    v_and_b32 v147, 0xffff0000, v129
    v_lshlrev_b32 v148, 16, v130
    v_and_b32 v149, 0xffff0000, v130
    v_lshlrev_b32 v150, 16, v131
    v_and_b32 v151, 0xffff0000, v131
    v_pk_mul_f32 v[144:145], v[144:145], s[30:31] op_sel_hi:[1,0]
    v_pk_mul_f32 v[146:147], v[146:147], s[30:31] op_sel_hi:[1,0]
    v_pk_mul_f32 v[148:149], v[148:149], s[30:31] op_sel_hi:[1,0]
    v_pk_mul_f32 v[150:151], v[150:151], s[30:31] op_sel_hi:[1,0]
    v_cvt_pk_bf16_f32 v144, v144, v145
    v_cvt_pk_bf16_f32 v146, v146, v147
    v_cvt_pk_bf16_f32 v148, v148, v149
    v_cvt_pk_bf16_f32 v150, v150, v151
    v_accvgpr_write_b32 a96, v144
    v_accvgpr_write_b32 a97, v146
    v_accvgpr_write_b32 a98, v148
    v_accvgpr_write_b32 a99, v150
    v_lshlrev_b32 v144, 16, v132
    v_and_b32 v145, 0xffff0000, v132
    v_lshlrev_b32 v146, 16, v133
    v_and_b32 v147, 0xffff0000, v133
    v_lshlrev_b32 v148, 16, v134
    v_and_b32 v149, 0xffff0000, v134
    v_lshlrev_b32 v150, 16, v135
    v_and_b32 v151, 0xffff0000, v135
    v_pk_mul_f32 v[144:145], v[144:145], s[30:31] op_sel_hi:[1,0]
    v_pk_mul_f32 v[146:147], v[146:147], s[30:31] op_sel_hi:[1,0]
    v_pk_mul_f32 v[148:149], v[148:149], s[30:31] op_sel_hi:[1,0]
    v_pk_mul_f32 v[150:151], v[150:151], s[30:31] op_sel_hi:[1,0]
    v_cvt_pk_bf16_f32 v144, v144, v145
    v_cvt_pk_bf16_f32 v146, v146, v147
    v_cvt_pk_bf16_f32 v148, v148, v149
    v_cvt_pk_bf16_f32 v150, v150, v151
    v_accvgpr_write_b32 a100, v144
    v_accvgpr_write_b32 a101, v146
    v_accvgpr_write_b32 a102, v148
    v_accvgpr_write_b32 a103, v150
    v_lshlrev_b32 v144, 16, v136
    v_and_b32 v145, 0xffff0000, v136
    v_lshlrev_b32 v146, 16, v137
    v_and_b32 v147, 0xffff0000, v137
    v_lshlrev_b32 v148, 16, v138
    v_and_b32 v149, 0xffff0000, v138
    v_lshlrev_b32 v150, 16, v139
    v_and_b32 v151, 0xffff0000, v139
    v_pk_mul_f32 v[144:145], v[144:145], s[30:31] op_sel_hi:[1,0]
    v_pk_mul_f32 v[146:147], v[146:147], s[30:31] op_sel_hi:[1,0]
    v_pk_mul_f32 v[148:149], v[148:149], s[30:31] op_sel_hi:[1,0]
    v_pk_mul_f32 v[150:151], v[150:151], s[30:31] op_sel_hi:[1,0]
    v_cvt_pk_bf16_f32 v144, v144, v145
    v_cvt_pk_bf16_f32 v146, v146, v147
    v_cvt_pk_bf16_f32 v148, v148, v149
    v_cvt_pk_bf16_f32 v150, v150, v151
    v_accvgpr_write_b32 a104, v144
    v_accvgpr_write_b32 a105, v146
    v_accvgpr_write_b32 a106, v148
    v_accvgpr_write_b32 a107, v150
    v_lshlrev_b32 v144, 16, v140
    v_and_b32 v145, 0xffff0000, v140
    v_lshlrev_b32 v146, 16, v141
    v_and_b32 v147, 0xffff0000, v141
    v_lshlrev_b32 v148, 16, v142
    v_and_b32 v149, 0xffff0000, v142
    v_lshlrev_b32 v150, 16, v143
    v_and_b32 v151, 0xffff0000, v143
    v_pk_mul_f32 v[144:145], v[144:145], s[30:31] op_sel_hi:[1,0]
    v_pk_mul_f32 v[146:147], v[146:147], s[30:31] op_sel_hi:[1,0]
    v_pk_mul_f32 v[148:149], v[148:149], s[30:31] op_sel_hi:[1,0]
    v_pk_mul_f32 v[150:151], v[150:151], s[30:31] op_sel_hi:[1,0]
    v_cvt_pk_bf16_f32 v144, v144, v145
    v_cvt_pk_bf16_f32 v146, v146, v147
    v_cvt_pk_bf16_f32 v148, v148, v149
    v_cvt_pk_bf16_f32 v150, v150, v151
    v_accvgpr_write_b32 a108, v144
    v_accvgpr_write_b32 a109, v146
    v_accvgpr_write_b32 a110, v148
    v_accvgpr_write_b32 a111, v150
    s_mov_b32 s35, 0
L_maxloop:
    buffer_load_dwordx4 v[128:131], v154, s[16:19], s35 offen offset:0
    buffer_load_dwordx4 v[132:135], v154, s[16:19], s35 offen offset:64
    buffer_load_dwordx4 v[136:139], v154, s[16:19], s35 offen offset:128
    buffer_load_dwordx4 v[140:143], v154, s[16:19], s35 offen offset:192
    s_waitcnt vmcnt(0)
    v_mfma_f32_16x16x32_bf16 v[32:35], v[128:131], a[48:51], 0
    v_mfma_f32_16x16x32_bf16 v[32:35], v[132:135], a[52:55], v[32:35]
    v_mfma_f32_16x16x32_bf16 v[32:35], v[136:139], a[56:59], v[32:35]
    v_mfma_f32_16x16x32_bf16 v[32:35], v[140:143], a[60:63], v[32:35]
    v_mfma_f32_16x16x32_bf16 v[36:39], v[128:131], a[64:67], 0
    v_mfma_f32_16x16x32_bf16 v[36:39], v[132:135], a[68:71], v[36:39]
    v_mfma_f32_16x16x32_bf16 v[36:39], v[136:139], a[72:75], v[36:39]
    v_mfma_f32_16x16x32_bf16 v[36:39], v[140:143], a[76:79], v[36:39]
    v_mfma_f32_16x16x32_bf16 v[40:43], v[128:131], a[80:83], 0
    v_mfma_f32_16x16x32_bf16 v[40:43], v[132:135], a[84:87], v[40:43]
    v_mfma_f32_16x16x32_bf16 v[40:43], v[136:139], a[88:91], v[40:43]
    v_mfma_f32_16x16x32_bf16 v[40:43], v[140:143], a[92:95], v[40:43]
    v_mfma_f32_16x16x32_bf16 v[44:47], v[128:131], a[96:99], 0
    v_mfma_f32_16x16x32_bf16 v[44:47], v[132:135], a[100:103], v[44:47]
    v_mfma_f32_16x16x32_bf16 v[44:47], v[136:139], a[104:107], v[44:47]
    v_mfma_f32_16x16x32_bf16 v[44:47], v[140:143], a[108:111], v[44:47]
    s_nop 7
    v_max3_f32 v16, v32, v33, v16
    v_max3_f32 v16, v34, v35, v16
    v_max3_f32 v20, v36, v37, v20
    v_max3_f32 v20, v38, v39, v20
    v_max3_f32 v24, v40, v41, v24
    v_max3_f32 v24, v42, v43, v24
    v_max3_f32 v28, v44, v45, v28
    v_max3_f32 v28, v46, v47, v28
    s_add_u32 s35, s35, 4096
    s_cmp_lt_u32 s35, 131072
    s_cbranch_scc1 L_maxloop
    s_nop 3
    s_branch L_maxdone
.section .rodata,"a"
.p2align 6
.amdhsa_kernel standalone__gqa_softmax__near_ridge_kernel
  .amdhsa_next_free_vgpr 512
  .amdhsa_next_free_sgpr 102
  .amdhsa_accum_offset 256
  .amdhsa_group_segment_fixed_size 0
  .amdhsa_kernarg_size 48
  .amdhsa_user_sgpr_count 2
  .amdhsa_user_sgpr_kernarg_segment_ptr 1
  .amdhsa_system_sgpr_workgroup_id_x 1
.end_amdhsa_kernel
```
